```python
import torch

def _softmax(x, axis=-1):
    return torch.softmax(x, dim=axis)
def _gelu(x):
    return torch.nn.functional.gelu(x, approximate="tanh")
def _silu(x):
    return torch.nn.functional.silu(x)
def _sigmoid(x):
    return torch.sigmoid(x)
def _layernorm(x, axis=-1, eps=1e-5):
    m = x.mean(dim=axis, keepdim=True)
    v = x.var(dim=axis, keepdim=True, unbiased=False)
    return (x - m) / torch.sqrt(v + eps)
def _scatter_add(tgt, idx, src, axis=0):
    return tgt.clone().index_add_(axis, idx, src)
def _segment_sum(src, seg, n):
    out = torch.zeros((n,) + src.shape[1:], dtype=src.dtype)
    return out.index_add_(0, seg, src)
def _pad(x, pw):
    flat = tuple(v for pair in reversed(pw) for v in pair)
    return torch.nn.functional.pad(x, flat)

kernel_name = 'parallel_sum__compressed_kv_cla__dense_activation_squared_relu__decode'

def setup_inputs():

    _w = (lambda a: (lambda t: t.to(torch.bfloat16) if t.is_floating_point() else t)(torch.as_tensor(a)))
    def _A_setup():
        B, H, Sq, Sk, D, M = 4, 32, 1, 4096, 128, 512
        Dc = 4 * D
        return {
            "x": _w((lambda *s: torch.randn(*s, dtype=torch.bfloat16) * 0.05)(B, Sq, M)),
            "c_kv": _w((lambda *s: torch.randn(*s, dtype=torch.bfloat16) * 3.2)(B, Sk, Dc)),
            "w_q": _w((lambda *s: torch.randn(*s, dtype=torch.bfloat16) * 1.6)(M, H, D) * (M ** -0.5)),
            "w_uk": _w((lambda *s: torch.randn(*s, dtype=torch.bfloat16) * 1.6)(Dc, H, D) * (Dc ** -0.5)),
            "w_uv": _w((lambda *s: torch.randn(*s, dtype=torch.bfloat16) * 3.2)(Dc, H, D) * (Dc ** -0.5)),
            "w_o": _w((lambda *s: torch.randn(*s, dtype=torch.bfloat16) * 3.2)(H, D, M) * ((H * D) ** -0.5)),
        }
    _A_in = _A_setup()

    def _B_setup():
        B, S, D, F = 4, 1, 512, 1792
        return {
            "x": _w((lambda *s: torch.randn(*s, dtype=torch.bfloat16) * 0.05)(B, S, D)),
            "w1": _w((lambda *s: torch.randn(*s, dtype=torch.bfloat16) * 0.1)(D, F)),
            "b1": _w((lambda *s: torch.randn(*s, dtype=torch.bfloat16) * 0.8)(F)),
            "w2": _w((lambda *s: torch.randn(*s, dtype=torch.bfloat16) * 0.1)(F, D)),
            "b2": _w((lambda *s: torch.randn(*s, dtype=torch.bfloat16) * 12.8)(D)),
        }
    _B_in = _B_setup()

    return {
        "A_x": _A_in["x"],
        "A_c_kv": _A_in["c_kv"],
        "A_w_q": _A_in["w_q"],
        "A_w_uk": _A_in["w_uk"],
        "A_w_uv": _A_in["w_uv"],
        "A_w_o": _A_in["w_o"],
        "B_x": _B_in["x"],
        "B_w1": _B_in["w1"],
        "B_b1": _B_in["b1"],
        "B_w2": _B_in["w2"],
        "B_b2": _B_in["b2"],
    }

def reference(A_x, A_c_kv, A_w_q, A_w_uk, A_w_uv, A_w_o, B_x, B_w1, B_b1, B_w2, B_b2):
    def _A_ref(x, c_kv, w_q, w_uk, w_uv, w_o):
        B, Sq, M = x.shape[0], x.shape[1], x.shape[2]
        Sk = c_kv.shape[1]
        H, D = w_q.shape[1], w_q.shape[2]
        q = torch.einsum("bqm,mhd->bhqd", x, w_q)
        k = torch.einsum("bkc,chd->bhkd", c_kv, w_uk)
        v = torch.einsum("bkc,chd->bhkd", c_kv, w_uv)
        scores = torch.einsum("bhqd,bhkd->bhqk", q, k) * (D ** -0.5)
        off = Sk - Sq
        qi = torch.arange(Sq)[:, None]
        kj = torch.arange(Sk)[None, :]
        cmask = kj <= (qi + off)
        scores = torch.where(cmask[None, None], scores, -1e9)
        p = _softmax(scores, axis=-1)
        ctx = torch.einsum("bhqk,bhkd->bhqd", p, v)
        return torch.einsum("bhqd,hdm->bqm", ctx, w_o)

    def _B_ref(x, w1, b1, w2, b2):
        h = torch.einsum("bsd,df->bsf", x, w1) + b1
        zero = torch.zeros_like(h)
        r = torch.where(h > zero, h, zero)
        h = r * r
        out = torch.einsum("bsf,fd->bsd", h, w2) + b2
        return out

    x = A_x
    xn = _layernorm(x, axis=-1)
    return x + _A_ref(xn, A_c_kv, A_w_q, A_w_uk, A_w_uv, A_w_o) + _B_ref(xn, B_w1, B_b1, B_w2, B_b2)
```

```asm
; @launch grid=(256,1,1) block=(512,1,1) lds=163840
.amdgcn_target "amdgcn-amd-amdhsa--gfx950"
.text
.globl parallel_sum__compressed_kv_cla__dense_activation_squared_relu__decode_kernel
.p2align 8
.type parallel_sum__compressed_kv_cla__dense_activation_squared_relu__decode_kernel,@function
parallel_sum__compressed_kv_cla__dense_activation_squared_relu__decode_kernel:
    s_cmp_ge_u32 s2, 256
    s_cbranch_scc1 L_end
    s_load_dwordx2 s[4:5], s[0:1], 0
    s_load_dwordx2 s[48:49], s[0:1], 96
    s_load_dwordx2 s[12:13], s[0:1], 16
    s_load_dwordx2 s[16:17], s[0:1], 24
    s_load_dwordx2 s[8:9], s[0:1], 8
    s_load_dwordx2 s[52:53], s[0:1], 104
    s_load_dwordx2 s[24:25], s[0:1], 40
    s_load_dwordx2 s[28:29], s[0:1], 56
    s_load_dwordx2 s[36:37], s[0:1], 72
    s_load_dwordx2 s[32:33], s[0:1], 64
    s_load_dwordx2 s[20:21], s[0:1], 32
    s_load_dwordx2 s[40:41], s[0:1], 80
    s_load_dwordx2 s[44:45], s[0:1], 88
    s_mov_b32 s6, 0x1000
    s_mov_b32 s7, 0x00020000
    s_mov_b32 s10, 0x1000000
    s_mov_b32 s11, 0x00020000
    s_mov_b32 s14, 0x400000
    s_mov_b32 s15, 0x00020000
    s_mov_b32 s18, 0x400000
    s_mov_b32 s19, 0x00020000
    s_mov_b32 s22, 0x400000
    s_mov_b32 s23, 0x00020000
    s_mov_b32 s26, 0x400000
    s_mov_b32 s27, 0x00020000
    s_mov_b32 s30, 0x1c0000
    s_mov_b32 s31, 0x00020000
    s_mov_b32 s34, 0xe00
    s_mov_b32 s35, 0x00020000
    s_mov_b32 s38, 0x1c0000
    s_mov_b32 s39, 0x00020000
    s_mov_b32 s42, 0x400
    s_mov_b32 s43, 0x00020000
    s_mov_b32 s46, 0x1000
    s_mov_b32 s47, 0x00020000
    s_mov_b32 s50, 0x100
    s_mov_b32 s51, 0x00020000
    s_mov_b32 s54, 0x10000000
    s_mov_b32 s55, 0x00020000
    v_lshrrev_b32 v3, 6, v0
    v_and_b32 v0, 63, v0
    v_readfirstlane_b32 s56, v3
    v_and_b32 v1, 15, v0
    v_lshrrev_b32 v2, 4, v0
    s_and_b32 s72, s2, 7
    s_lshr_b32 s73, s2, 3
    s_lshr_b32 s74, s73, 3
    s_lshl_b32 s57, s72, 2
    s_add_u32 s57, s57, s74
    s_and_b32 s58, s73, 7
    s_lshr_b32 s74, s73, 1
    s_lshl_b32 s62, s72, 4
    s_add_u32 s62, s62, s74
    s_and_b32 s61, s73, 1
    s_lshr_b32 s59, s62, 5
    s_and_b32 s60, s62, 31
    s_mul_i32 s63, s72, 28
    s_add_u32 s63, s63, s73
    s_lshl_b32 s63, s63, 3
    s_cmp_lt_u32 s73, 28
    s_cselect_b32 s63, s63, 1792
    s_mov_b32 s68, 0xfffff000
    s_mov_b32 s69, 0x05040100
    s_mov_b32 s70, 0x07060302
    s_mov_b32 s71, 0x3e0293ee
    s_mov_b32 s82, 0
    s_mov_b32 s88, 0x3ff
    s_mov_b32 s89, 0xffc00
    s_mov_b32 s90, 0x3ff00000
    s_mov_b32 s91, 0x4b400000
    s_and_b32 s83, s56, 3
    v_lshlrev_b32 v8, 4, v0
    v_mov_b32 v9, 0
    s_cmp_ge_u32 s56, 4
    s_cbranch_scc1 L_loader
    v_lshlrev_b32 v5, 16, v2
    v_lshl_add_u32 v5, v1, 3, v5
    v_lshlrev_b32 v6, 13, v1
    v_lshl_add_u32 v6, v2, 4, v6
    s_waitcnt lgkmcnt(0)
    s_cmp_ge_u32 s2, 8
    s_cbranch_scc1 L_nonce_1
    s_cmp_lg_u32 s56, 3
    s_cbranch_scc1 L_nonce_1
    s_memrealtime s[76:77]
    v_mov_b32 v18, 0
    v_mov_b32 v19, 0
    s_waitcnt lgkmcnt(0)
    s_or_b32 s77, s77, 0x80000000
    v_mov_b32 v16, s76
    v_mov_b32 v17, s77
    s_mov_b64 exec, 1
    buffer_atomic_cmpswap_x2 v[16:19], v9, s[48:51], 0 offen sc1
    s_mov_b64 exec, -1
L_nonce_1:
    s_barrier
    s_lshl_b32 s73, s57, 8
    s_and_b32 s74, s58, 1
    s_lshl_b32 s74, s74, 7
    s_add_u32 s73, s73, s74
    s_lshr_b32 s72, s58, 1
    s_lshl_b32 s72, s72, 20
    s_lshl_b32 s74, s56, 18
    s_add_u32 s72, s72, s74
    s_add_u32 s72, s72, s73
    s_add_u32 s74, s72, 131072
    buffer_load_dwordx4 v[224:227], v6, s[16:19], s72 offen offset:0
    buffer_load_dwordx4 v[228:231], v6, s[16:19], s72 offen offset:64
    buffer_load_dwordx4 v[232:235], v6, s[16:19], s74 offen offset:0
    buffer_load_dwordx4 v[236:239], v6, s[16:19], s74 offen offset:64
    s_lshl_b32 s75, s56, 20
    s_add_u32 s75, s75, s73
    s_lshr_b32 s74, s58, 1
    s_add_u32 s72, s74, 0
    s_and_b32 s72, s72, 3
    s_lshl_b32 s72, s72, 18
    s_add_u32 s72, s72, s75
    buffer_load_dwordx2 v[96:97], v5, s[12:15], s72 offen
    s_add_u32 s72, s72, 8192
    buffer_load_dwordx2 v[98:99], v5, s[12:15], s72 offen
    s_add_u32 s72, s72, 8192
    buffer_load_dwordx2 v[100:101], v5, s[12:15], s72 offen
    s_add_u32 s72, s72, 8192
    buffer_load_dwordx2 v[102:103], v5, s[12:15], s72 offen
    s_add_u32 s72, s72, 8192
    buffer_load_dwordx2 v[104:105], v5, s[12:15], s72 offen
    s_add_u32 s72, s72, 8192
    buffer_load_dwordx2 v[106:107], v5, s[12:15], s72 offen
    s_add_u32 s72, s72, 8192
    buffer_load_dwordx2 v[108:109], v5, s[12:15], s72 offen
    s_add_u32 s72, s72, 8192
    buffer_load_dwordx2 v[110:111], v5, s[12:15], s72 offen
    s_add_u32 s72, s74, 1
    s_and_b32 s72, s72, 3
    s_lshl_b32 s72, s72, 18
    s_add_u32 s72, s72, s75
    buffer_load_dwordx2 v[112:113], v5, s[12:15], s72 offen
    s_add_u32 s72, s72, 8192
    buffer_load_dwordx2 v[114:115], v5, s[12:15], s72 offen
    s_add_u32 s72, s72, 8192
    buffer_load_dwordx2 v[116:117], v5, s[12:15], s72 offen
    s_add_u32 s72, s72, 8192
    buffer_load_dwordx2 v[118:119], v5, s[12:15], s72 offen
    s_add_u32 s72, s72, 8192
    buffer_load_dwordx2 v[120:121], v5, s[12:15], s72 offen
    s_add_u32 s72, s72, 8192
    buffer_load_dwordx2 v[122:123], v5, s[12:15], s72 offen
    s_add_u32 s72, s72, 8192
    buffer_load_dwordx2 v[124:125], v5, s[12:15], s72 offen
    s_add_u32 s72, s72, 8192
    buffer_load_dwordx2 v[126:127], v5, s[12:15], s72 offen
    s_add_u32 s72, s74, 2
    s_and_b32 s72, s72, 3
    s_lshl_b32 s72, s72, 18
    s_add_u32 s72, s72, s75
    buffer_load_dwordx2 v[128:129], v5, s[12:15], s72 offen
    s_add_u32 s72, s72, 8192
    buffer_load_dwordx2 v[130:131], v5, s[12:15], s72 offen
    s_add_u32 s72, s72, 8192
    buffer_load_dwordx2 v[132:133], v5, s[12:15], s72 offen
    s_add_u32 s72, s72, 8192
    buffer_load_dwordx2 v[134:135], v5, s[12:15], s72 offen
    s_add_u32 s72, s72, 8192
    buffer_load_dwordx2 v[136:137], v5, s[12:15], s72 offen
    s_add_u32 s72, s72, 8192
    buffer_load_dwordx2 v[138:139], v5, s[12:15], s72 offen
    s_add_u32 s72, s72, 8192
    buffer_load_dwordx2 v[140:141], v5, s[12:15], s72 offen
    s_add_u32 s72, s72, 8192
    buffer_load_dwordx2 v[142:143], v5, s[12:15], s72 offen
    s_add_u32 s72, s74, 3
    s_and_b32 s72, s72, 3
    s_lshl_b32 s72, s72, 18
    s_add_u32 s72, s72, s75
    buffer_load_dwordx2 v[144:145], v5, s[12:15], s72 offen
    s_add_u32 s72, s72, 8192
    buffer_load_dwordx2 v[146:147], v5, s[12:15], s72 offen
    s_add_u32 s72, s72, 8192
    buffer_load_dwordx2 v[148:149], v5, s[12:15], s72 offen
    s_add_u32 s72, s72, 8192
    buffer_load_dwordx2 v[150:151], v5, s[12:15], s72 offen
    s_add_u32 s72, s72, 8192
    buffer_load_dwordx2 v[152:153], v5, s[12:15], s72 offen
    s_add_u32 s72, s72, 8192
    buffer_load_dwordx2 v[154:155], v5, s[12:15], s72 offen
    s_add_u32 s72, s72, 8192
    buffer_load_dwordx2 v[156:157], v5, s[12:15], s72 offen
    s_add_u32 s72, s72, 8192
    buffer_load_dwordx2 v[158:159], v5, s[12:15], s72 offen
    v_and_b32 v4, 3, v1
    v_lshlrev_b32 v4, 10, v4
    v_lshl_add_u32 v4, v2, 4, v4
    s_lshl_b32 s72, s83, 8
    v_add_u32 v4, s72, v4
L_cw_2:
    ds_read_b32 v3, v9 offset:27936
    s_add_u32 s82, s82, 1
    s_cmp_gt_u32 s82, 0x60000000
    s_cbranch_scc1 L_cwok_3
    s_waitcnt lgkmcnt(0)
    v_readfirstlane_b32 s100, v3
    s_cmp_ge_u32 s100, 4
    s_cbranch_scc0 L_cw_2
L_cwok_3:
    s_waitcnt lgkmcnt(0)
    s_add_u32 s72, s74, 0
    s_and_b32 s72, s72, 3
    s_lshl_b32 s72, s72, 6
    v_add_u32 v5, s72, v4
    ds_read_b128 v[16:19], v5 offset:18432
    s_add_u32 s72, s74, 1
    s_and_b32 s72, s72, 3
    s_lshl_b32 s72, s72, 6
    v_add_u32 v5, s72, v4
    ds_read_b128 v[20:23], v5 offset:18432
    s_add_u32 s72, s74, 2
    s_and_b32 s72, s72, 3
    s_lshl_b32 s72, s72, 6
    v_add_u32 v5, s72, v4
    ds_read_b128 v[24:27], v5 offset:18432
    s_add_u32 s72, s74, 3
    s_and_b32 s72, s72, 3
    s_lshl_b32 s72, s72, 6
    v_add_u32 v5, s72, v4
    ds_read_b128 v[28:31], v5 offset:18432
    s_lshl_b32 s72, s56, 10
    v_lshlrev_b32 v5, 6, v1
    v_add_u32 v5, s72, v5
    s_waitcnt vmcnt(24) lgkmcnt(0)
    v_perm_b32 v160, v98, v96, s69
    v_perm_b32 v161, v102, v100, s69
    v_perm_b32 v162, v106, v104, s69
    v_perm_b32 v163, v110, v108, s69
    v_perm_b32 v164, v98, v96, s70
    v_perm_b32 v165, v102, v100, s70
    v_perm_b32 v166, v106, v104, s70
    v_perm_b32 v167, v110, v108, s70
    v_perm_b32 v168, v99, v97, s69
    v_perm_b32 v169, v103, v101, s69
    v_perm_b32 v170, v107, v105, s69
    v_perm_b32 v171, v111, v109, s69
    v_perm_b32 v172, v99, v97, s70
    v_perm_b32 v173, v103, v101, s70
    v_perm_b32 v174, v107, v105, s70
    v_perm_b32 v175, v111, v109, s70
    s_nop 0
    v_mfma_f32_16x16x32_bf16 v[176:179], v[16:19], v[160:163], 0
    v_mfma_f32_16x16x32_bf16 v[180:183], v[16:19], v[164:167], 0
    v_mfma_f32_16x16x32_bf16 v[184:187], v[16:19], v[168:171], 0
    v_mfma_f32_16x16x32_bf16 v[188:191], v[16:19], v[172:175], 0
    s_waitcnt vmcnt(16)
    v_perm_b32 v160, v114, v112, s69
    v_perm_b32 v161, v118, v116, s69
    v_perm_b32 v162, v122, v120, s69
    v_perm_b32 v163, v126, v124, s69
    v_perm_b32 v164, v114, v112, s70
    v_perm_b32 v165, v118, v116, s70
    v_perm_b32 v166, v122, v120, s70
    v_perm_b32 v167, v126, v124, s70
    v_perm_b32 v168, v115, v113, s69
    v_perm_b32 v169, v119, v117, s69
    v_perm_b32 v170, v123, v121, s69
    v_perm_b32 v171, v127, v125, s69
    v_perm_b32 v172, v115, v113, s70
    v_perm_b32 v173, v119, v117, s70
    v_perm_b32 v174, v123, v121, s70
    v_perm_b32 v175, v127, v125, s70
    s_nop 0
    v_mfma_f32_16x16x32_bf16 v[176:179], v[20:23], v[160:163], v[176:179]
    v_mfma_f32_16x16x32_bf16 v[180:183], v[20:23], v[164:167], v[180:183]
    v_mfma_f32_16x16x32_bf16 v[184:187], v[20:23], v[168:171], v[184:187]
    v_mfma_f32_16x16x32_bf16 v[188:191], v[20:23], v[172:175], v[188:191]
    s_waitcnt vmcnt(8)
    v_perm_b32 v160, v130, v128, s69
    v_perm_b32 v161, v134, v132, s69
    v_perm_b32 v162, v138, v136, s69
    v_perm_b32 v163, v142, v140, s69
    v_perm_b32 v164, v130, v128, s70
    v_perm_b32 v165, v134, v132, s70
    v_perm_b32 v166, v138, v136, s70
    v_perm_b32 v167, v142, v140, s70
    v_perm_b32 v168, v131, v129, s69
    v_perm_b32 v169, v135, v133, s69
    v_perm_b32 v170, v139, v137, s69
    v_perm_b32 v171, v143, v141, s69
    v_perm_b32 v172, v131, v129, s70
    v_perm_b32 v173, v135, v133, s70
    v_perm_b32 v174, v139, v137, s70
    v_perm_b32 v175, v143, v141, s70
    s_nop 0
    v_mfma_f32_16x16x32_bf16 v[176:179], v[24:27], v[160:163], v[176:179]
    v_mfma_f32_16x16x32_bf16 v[180:183], v[24:27], v[164:167], v[180:183]
    v_mfma_f32_16x16x32_bf16 v[184:187], v[24:27], v[168:171], v[184:187]
    v_mfma_f32_16x16x32_bf16 v[188:191], v[24:27], v[172:175], v[188:191]
L_cw_4:
    ds_read_b32 v3, v9 offset:27952
    s_add_u32 s82, s82, 1
    s_cmp_gt_u32 s82, 0x60000000
    s_cbranch_scc1 L_cwok_5
    s_waitcnt lgkmcnt(0)
    v_readfirstlane_b32 s100, v3
    s_cmp_ge_u32 s100, 1
    s_cbranch_scc0 L_cw_4
L_cwok_5:
    s_waitcnt lgkmcnt(0)
    ds_read_b64 v[10:11], v9 offset:27904
    s_waitcnt lgkmcnt(0)
    v_readfirstlane_b32 s76, v10
    v_readfirstlane_b32 s77, v11
    s_nop 0
    s_and_b32 s64, s76, 0xfff
    s_bfe_u32 s65, s76, 0xc000c
    s_lshr_b64 s[76:77], s[76:77], 24
    s_and_b32 s66, s76, 0xfff
    s_bfe_u32 s67, s76, 0xc000c
    v_mov_b32 v12, s64
    v_mov_b32 v13, s65
    v_mov_b32 v14, s66
    v_mov_b32 v15, s67
    v_readfirstlane_b32 s87, v10
    s_lshr_b32 s76, s76, 8
    s_lshl_b32 s84, s76, 30
    s_lshr_b32 s76, s76, 2
    s_lshl_b32 s85, s76, 30
    s_lshr_b32 s76, s76, 2
    s_lshl_b32 s86, s76, 28
    v_mov_b32 v250, s84
    v_mov_b32 v251, s85
    v_mov_b32 v252, s86
    v_mov_b32 v253, s87
    s_waitcnt vmcnt(0)
    v_perm_b32 v160, v146, v144, s69
    v_perm_b32 v161, v150, v148, s69
    v_perm_b32 v162, v154, v152, s69
    v_perm_b32 v163, v158, v156, s69
    v_perm_b32 v164, v146, v144, s70
    v_perm_b32 v165, v150, v148, s70
    v_perm_b32 v166, v154, v152, s70
    v_perm_b32 v167, v158, v156, s70
    v_perm_b32 v168, v147, v145, s69
    v_perm_b32 v169, v151, v149, s69
    v_perm_b32 v170, v155, v153, s69
    v_perm_b32 v171, v159, v157, s69
    v_perm_b32 v172, v147, v145, s70
    v_perm_b32 v173, v151, v149, s70
    v_perm_b32 v174, v155, v153, s70
    v_perm_b32 v175, v159, v157, s70
    s_nop 0
    v_mfma_f32_16x16x32_bf16 v[176:179], v[28:31], v[160:163], v[176:179]
    v_mfma_f32_16x16x32_bf16 v[180:183], v[28:31], v[164:167], v[180:183]
    v_mfma_f32_16x16x32_bf16 v[184:187], v[28:31], v[168:171], v[184:187]
    v_mfma_f32_16x16x32_bf16 v[188:191], v[28:31], v[172:175], v[188:191]
    s_mov_b64 exec, 0xffff
    s_nop 4
    ds_write_b128 v5, v[176:179] offset:0
    ds_write_b128 v5, v[180:183] offset:16
    ds_write_b128 v5, v[184:187] offset:32
    ds_write_b128 v5, v[188:191] offset:48
    s_mov_b64 exec, -1
    v_mov_b32 v3, 1
    s_mov_b64 exec, 1
    ds_add_u32 v9, v3 offset:27920
    s_mov_b64 exec, -1
    s_lshl_b32 s72, s56, 8
    v_lshlrev_b32 v6, 2, v0
    v_add_u32 v6, s72, v6
    v_and_b32 v5, 3, v0
    v_lshlrev_b32 v5, 7, v5
    v_lshrrev_b32 v4, 2, v0
    v_lshl_add_u32 v5, v4, 1, v5
    s_lshl_b32 s72, s56, 5
    v_add_u32 v5, s72, v5
L_cw_6:
    ds_read_b32 v3, v9 offset:27920
    s_add_u32 s82, s82, 1
    s_cmp_gt_u32 s82, 0x60000000
    s_cbranch_scc1 L_cwok_7
    s_waitcnt lgkmcnt(0)
    v_readfirstlane_b32 s100, v3
    s_cmp_ge_u32 s100, 4
    s_cbranch_scc0 L_cw_6
L_cwok_7:
    s_waitcnt lgkmcnt(0)
    ds_read_b32 v160, v6 offset:0
    ds_read_b32 v161, v6 offset:1024
    ds_read_b32 v162, v6 offset:2048
    ds_read_b32 v163, v6 offset:3072
    s_waitcnt lgkmcnt(0)
    v_add_f32 v160, v160, v161
    v_add_f32 v162, v162, v163
    v_add_f32 v160, v160, v162
    v_cvt_pk_bf16_f32 v160, v160, v160
    ds_write_b16 v5, v160 offset:22528
    v_mov_b32 v3, 1
    s_mov_b64 exec, 1
    ds_add_u32 v9, v3 offset:27924
    s_mov_b64 exec, -1
    v_and_b32 v6, 3, v1
    v_lshlrev_b32 v4, 7, v6
    v_lshl_add_u32 v4, v2, 4, v4
    v_lshlrev_b32 v5, 15, v6
    v_lshl_add_u32 v5, v2, 4, v5
    s_and_b32 s72, s58, 1
    s_lshl_b32 s72, s72, 17
    s_lshl_b32 s73, s57, 10
    s_add_u32 s72, s72, s73
    s_lshr_b32 s73, s58, 1
    s_lshl_b32 s73, s73, 8
    s_add_u32 s72, s72, s73
    s_lshl_b32 s73, s56, 6
    s_add_u32 s72, s72, s73
L_cw_8:
    ds_read_b32 v3, v9 offset:27924
    s_add_u32 s82, s82, 1
    s_cmp_gt_u32 s82, 0x60000000
    s_cbranch_scc1 L_cwok_9
    s_waitcnt lgkmcnt(0)
    v_readfirstlane_b32 s100, v3
    s_cmp_ge_u32 s100, 4
    s_cbranch_scc0 L_cw_8
L_cwok_9:
    s_waitcnt lgkmcnt(0)
    ds_read_b128 v[160:163], v4 offset:22528
    ds_read_b128 v[164:167], v4 offset:22592
    s_waitcnt lgkmcnt(0)
    v_mfma_f32_16x16x32_bf16 v[176:179], v[224:227], v[160:163], 0
    v_mfma_f32_16x16x32_bf16 v[180:183], v[232:235], v[160:163], 0
    v_mfma_f32_16x16x32_bf16 v[176:179], v[228:231], v[164:167], v[176:179]
    v_mfma_f32_16x16x32_bf16 v[180:183], v[236:239], v[164:167], v[180:183]
    s_nop 7
    v_max3_f32 v3, |v176|, |v177|, |v178|
    v_max3_f32 v4, |v179|, |v180|, |v181|
    v_max3_f32 v3, |v182|, |v183|, v3
    v_max_f32 v3, v3, v4
    v_and_b32 v3, 0x7f800000, v3
    v_max_u32 v3, 0x08000000, v3
    v_sub_u32 v4, 0x82ff8000, v3
    v_fma_f32 v176, v176, v4, s91
    v_fma_f32 v177, v177, v4, s91
    v_fma_f32 v178, v178, v4, s91
    v_fma_f32 v179, v179, v4, s91
    v_fma_f32 v180, v180, v4, s91
    v_fma_f32 v181, v181, v4, s91
    v_fma_f32 v182, v182, v4, s91
    v_fma_f32 v183, v183, v4, s91
    v_lshrrev_b32 v3, 3, v3
    v_lshlrev_b32 v177, 10, v177
    v_lshlrev_b32 v180, 10, v180
    v_lshlrev_b32 v183, 10, v183
    v_lshlrev_b32 v178, 20, v178
    v_lshlrev_b32 v181, 20, v181
    v_or_b32 v3, v3, v252
    v_bfi_b32 v176, s88, v176, v250
    v_bfi_b32 v179, s88, v179, v251
    v_bfi_b32 v182, s88, v182, v3
    v_bfi_b32 v176, s89, v177, v176
    v_bfi_b32 v179, s89, v180, v179
    v_bfi_b32 v186, s89, v183, v182
    v_bfi_b32 v184, s90, v178, v176
    v_bfi_b32 v185, s90, v181, v179
    v_mov_b32 v187, v253
    s_mov_b32 exec_lo, 0x000f000f
    s_mov_b32 exec_hi, 0x000f000f
    buffer_store_dwordx4 v[184:187], v5, s[52:55], s72 offen sc1
    s_mov_b64 exec, -1
    s_lshl_b32 s75, s59, 15
    s_lshl_b32 s72, s61, 14
    s_add_u32 s75, s75, s72
    s_lshl_b32 s72, s56, 12
    s_add_u32 s75, s75, s72
    s_add_u32 s74, s75, 131072
    v_lshrrev_b32 v6, 2, v1
    v_lshl_add_u32 v6, v2, 2, v6
    v_mul_u32_u24 v6, 1056, v6
    v_and_b32 v7, 3, v1
    v_lshl_add_u32 v6, v7, 3, v6
    s_lshl_b32 s72, s56, 7
    s_add_u32 s72, s72, 28672
    v_add_u32 v6, s72, v6
    v_add_u32 v7, 67584, v6
    s_lshl_b32 s72, s56, 4
    v_add_u32 v5, s72, v1
    v_mul_u32_u24 v5, 1056, v5
    v_lshl_add_u32 v5, v2, 4, v5
    v_add_u32 v5, 28672, v5
    s_sleep 20
    buffer_load_dwordx4 v[32:35], v8, s[52:55], s75 offen offset:0 sc1
    buffer_load_dwordx4 v[36:39], v8, s[52:55], s74 offen offset:0 sc1
    buffer_load_dwordx4 v[40:43], v8, s[52:55], s75 offen offset:1024 sc1
    buffer_load_dwordx4 v[44:47], v8, s[52:55], s74 offen offset:1024 sc1
    buffer_load_dwordx4 v[48:51], v8, s[52:55], s75 offen offset:2048 sc1
    buffer_load_dwordx4 v[52:55], v8, s[52:55], s74 offen offset:2048 sc1
    buffer_load_dwordx4 v[56:59], v8, s[52:55], s75 offen offset:3072 sc1
    buffer_load_dwordx4 v[60:63], v8, s[52:55], s74 offen offset:3072 sc1
    s_mov_b32 s101, 255
    s_waitcnt vmcnt(0)
L_g_10:
    s_bitcmp1_b32 s101, 0
    s_cbranch_scc0 L_gs_12
    v_xor_b32 v3, s84, v32
    v_xor_b32 v4, s85, v33
    v_or_b32 v3, v3, v4
    v_xor_b32 v4, s86, v34
    v_lshrrev_b32 v3, 30, v3
    v_lshrrev_b32 v4, 28, v4
    v_xor_b32 v35, s87, v35
    v_or3_b32 v3, v3, v4, v35
    v_cmp_ne_u32 vcc, 0, v3
    s_bitset0_b32 s101, 0
    s_cbranch_vccz L_gs_12
    s_bitset1_b32 s101, 0
    buffer_load_dwordx4 v[32:35], v8, s[52:55], s75 offen offset:0 sc1
L_gs_12:
    s_bitcmp1_b32 s101, 1
    s_cbranch_scc0 L_gs_13
    v_xor_b32 v3, s84, v36
    v_xor_b32 v4, s85, v37
    v_or_b32 v3, v3, v4
    v_xor_b32 v4, s86, v38
    v_lshrrev_b32 v3, 30, v3
    v_lshrrev_b32 v4, 28, v4
    v_xor_b32 v39, s87, v39
    v_or3_b32 v3, v3, v4, v39
    v_cmp_ne_u32 vcc, 0, v3
    s_bitset0_b32 s101, 1
    s_cbranch_vccz L_gs_13
    s_bitset1_b32 s101, 1
    buffer_load_dwordx4 v[36:39], v8, s[52:55], s74 offen offset:0 sc1
L_gs_13:
    s_bitcmp1_b32 s101, 2
    s_cbranch_scc0 L_gs_14
    v_xor_b32 v3, s84, v40
    v_xor_b32 v4, s85, v41
    v_or_b32 v3, v3, v4
    v_xor_b32 v4, s86, v42
    v_lshrrev_b32 v3, 30, v3
    v_lshrrev_b32 v4, 28, v4
    v_xor_b32 v43, s87, v43
    v_or3_b32 v3, v3, v4, v43
    v_cmp_ne_u32 vcc, 0, v3
    s_bitset0_b32 s101, 2
    s_cbranch_vccz L_gs_14
    s_bitset1_b32 s101, 2
    buffer_load_dwordx4 v[40:43], v8, s[52:55], s75 offen offset:1024 sc1
L_gs_14:
    s_bitcmp1_b32 s101, 3
    s_cbranch_scc0 L_gs_15
    v_xor_b32 v3, s84, v44
    v_xor_b32 v4, s85, v45
    v_or_b32 v3, v3, v4
    v_xor_b32 v4, s86, v46
    v_lshrrev_b32 v3, 30, v3
    v_lshrrev_b32 v4, 28, v4
    v_xor_b32 v47, s87, v47
    v_or3_b32 v3, v3, v4, v47
    v_cmp_ne_u32 vcc, 0, v3
    s_bitset0_b32 s101, 3
    s_cbranch_vccz L_gs_15
    s_bitset1_b32 s101, 3
    buffer_load_dwordx4 v[44:47], v8, s[52:55], s74 offen offset:1024 sc1
L_gs_15:
    s_bitcmp1_b32 s101, 4
    s_cbranch_scc0 L_gs_16
    v_xor_b32 v3, s84, v48
    v_xor_b32 v4, s85, v49
    v_or_b32 v3, v3, v4
    v_xor_b32 v4, s86, v50
    v_lshrrev_b32 v3, 30, v3
    v_lshrrev_b32 v4, 28, v4
    v_xor_b32 v51, s87, v51
    v_or3_b32 v3, v3, v4, v51
    v_cmp_ne_u32 vcc, 0, v3
    s_bitset0_b32 s101, 4
    s_cbranch_vccz L_gs_16
    s_bitset1_b32 s101, 4
    buffer_load_dwordx4 v[48:51], v8, s[52:55], s75 offen offset:2048 sc1
L_gs_16:
    s_bitcmp1_b32 s101, 5
    s_cbranch_scc0 L_gs_17
    v_xor_b32 v3, s84, v52
    v_xor_b32 v4, s85, v53
    v_or_b32 v3, v3, v4
    v_xor_b32 v4, s86, v54
    v_lshrrev_b32 v3, 30, v3
    v_lshrrev_b32 v4, 28, v4
    v_xor_b32 v55, s87, v55
    v_or3_b32 v3, v3, v4, v55
    v_cmp_ne_u32 vcc, 0, v3
    s_bitset0_b32 s101, 5
    s_cbranch_vccz L_gs_17
    s_bitset1_b32 s101, 5
    buffer_load_dwordx4 v[52:55], v8, s[52:55], s74 offen offset:2048 sc1
L_gs_17:
    s_bitcmp1_b32 s101, 6
    s_cbranch_scc0 L_gs_18
    v_xor_b32 v3, s84, v56
    v_xor_b32 v4, s85, v57
    v_or_b32 v3, v3, v4
    v_xor_b32 v4, s86, v58
    v_lshrrev_b32 v3, 30, v3
    v_lshrrev_b32 v4, 28, v4
    v_xor_b32 v59, s87, v59
    v_or3_b32 v3, v3, v4, v59
    v_cmp_ne_u32 vcc, 0, v3
    s_bitset0_b32 s101, 6
    s_cbranch_vccz L_gs_18
    s_bitset1_b32 s101, 6
    buffer_load_dwordx4 v[56:59], v8, s[52:55], s75 offen offset:3072 sc1
L_gs_18:
    s_bitcmp1_b32 s101, 7
    s_cbranch_scc0 L_gs_19
    v_xor_b32 v3, s84, v60
    v_xor_b32 v4, s85, v61
    v_or_b32 v3, v3, v4
    v_xor_b32 v4, s86, v62
    v_lshrrev_b32 v3, 30, v3
    v_lshrrev_b32 v4, 28, v4
    v_xor_b32 v63, s87, v63
    v_or3_b32 v3, v3, v4, v63
    v_cmp_ne_u32 vcc, 0, v3
    s_bitset0_b32 s101, 7
    s_cbranch_vccz L_gs_19
    s_bitset1_b32 s101, 7
    buffer_load_dwordx4 v[60:63], v8, s[52:55], s74 offen offset:3072 sc1
L_gs_19:
    s_cmp_eq_u32 s101, 0
    s_cbranch_scc1 L_gdone_11
    s_add_u32 s82, s82, 0x10000
    s_cmp_gt_u32 s82, 0x40000000
    s_cbranch_scc1 L_gdone_11
    s_waitcnt vmcnt(0)
    s_branch L_g_10
L_gdone_11:
    s_mul_i32 s72, s56, 4224
    v_lshrrev_b32 v4, 2, v0
    v_lshlrev_b32 v4, 6, v4
    v_and_b32 v3, 3, v0
    v_lshl_add_u32 v4, v3, 3, v4
    v_add_u32 v4, s72, v4
    v_lshlrev_b32 v10, 3, v34
    v_bfe_i32 v64, v32, 0, 10
    v_bfe_i32 v65, v32, 10, 10
    v_bfe_i32 v66, v32, 20, 10
    v_bfe_i32 v67, v33, 0, 10
    v_bfe_i32 v68, v33, 10, 10
    v_bfe_i32 v69, v33, 20, 10
    v_bfe_i32 v70, v34, 0, 10
    v_bfe_i32 v71, v34, 10, 10
    v_and_b32 v10, 0x7f800000, v10
    v_cvt_f32_i32 v64, v64
    v_cvt_f32_i32 v65, v65
    v_cvt_f32_i32 v66, v66
    v_cvt_f32_i32 v67, v67
    v_cvt_f32_i32 v68, v68
    v_cvt_f32_i32 v69, v69
    v_cvt_f32_i32 v70, v70
    v_cvt_f32_i32 v71, v71
    v_add_u32 v10, 0xfc004020, v10
    v_lshlrev_b32 v11, 3, v38
    v_bfe_i32 v72, v36, 0, 10
    v_bfe_i32 v73, v36, 10, 10
    v_bfe_i32 v74, v36, 20, 10
    v_bfe_i32 v75, v37, 0, 10
    v_bfe_i32 v76, v37, 10, 10
    v_bfe_i32 v77, v37, 20, 10
    v_bfe_i32 v78, v38, 0, 10
    v_bfe_i32 v79, v38, 10, 10
    v_and_b32 v11, 0x7f800000, v11
    v_cvt_f32_i32 v72, v72
    v_cvt_f32_i32 v73, v73
    v_cvt_f32_i32 v74, v74
    v_cvt_f32_i32 v75, v75
    v_cvt_f32_i32 v76, v76
    v_cvt_f32_i32 v77, v77
    v_cvt_f32_i32 v78, v78
    v_cvt_f32_i32 v79, v79
    v_add_u32 v11, 0xfc004020, v11
    v_mul_f32 v64, v64, v10
    v_mul_f32 v65, v65, v10
    v_mul_f32 v66, v66, v10
    v_mul_f32 v67, v67, v10
    v_mul_f32 v68, v68, v10
    v_mul_f32 v69, v69, v10
    v_mul_f32 v70, v70, v10
    v_mul_f32 v71, v71, v10
    v_fmac_f32 v64, v72, v11
    v_fmac_f32 v65, v73, v11
    v_fmac_f32 v66, v74, v11
    v_fmac_f32 v67, v75, v11
    v_fmac_f32 v68, v76, v11
    v_fmac_f32 v69, v77, v11
    v_fmac_f32 v70, v78, v11
    v_fmac_f32 v71, v79, v11
    v_cvt_pk_bf16_f32 v32, v64, v65
    v_cvt_pk_bf16_f32 v33, v66, v67
    v_cvt_pk_bf16_f32 v34, v68, v69
    v_cvt_pk_bf16_f32 v35, v70, v71
    ds_write_b64 v4, v[32:33] offset:0
    ds_write_b64 v4, v[34:35] offset:32
    v_lshlrev_b32 v10, 3, v42
    v_bfe_i32 v64, v40, 0, 10
    v_bfe_i32 v65, v40, 10, 10
    v_bfe_i32 v66, v40, 20, 10
    v_bfe_i32 v67, v41, 0, 10
    v_bfe_i32 v68, v41, 10, 10
    v_bfe_i32 v69, v41, 20, 10
    v_bfe_i32 v70, v42, 0, 10
    v_bfe_i32 v71, v42, 10, 10
    v_and_b32 v10, 0x7f800000, v10
    v_cvt_f32_i32 v64, v64
    v_cvt_f32_i32 v65, v65
    v_cvt_f32_i32 v66, v66
    v_cvt_f32_i32 v67, v67
    v_cvt_f32_i32 v68, v68
    v_cvt_f32_i32 v69, v69
    v_cvt_f32_i32 v70, v70
    v_cvt_f32_i32 v71, v71
    v_add_u32 v10, 0xfc004020, v10
    v_lshlrev_b32 v11, 3, v46
    v_bfe_i32 v72, v44, 0, 10
    v_bfe_i32 v73, v44, 10, 10
    v_bfe_i32 v74, v44, 20, 10
    v_bfe_i32 v75, v45, 0, 10
    v_bfe_i32 v76, v45, 10, 10
    v_bfe_i32 v77, v45, 20, 10
    v_bfe_i32 v78, v46, 0, 10
    v_bfe_i32 v79, v46, 10, 10
    v_and_b32 v11, 0x7f800000, v11
    v_cvt_f32_i32 v72, v72
    v_cvt_f32_i32 v73, v73
    v_cvt_f32_i32 v74, v74
    v_cvt_f32_i32 v75, v75
    v_cvt_f32_i32 v76, v76
    v_cvt_f32_i32 v77, v77
    v_cvt_f32_i32 v78, v78
    v_cvt_f32_i32 v79, v79
    v_add_u32 v11, 0xfc004020, v11
    v_mul_f32 v64, v64, v10
    v_mul_f32 v65, v65, v10
    v_mul_f32 v66, v66, v10
    v_mul_f32 v67, v67, v10
    v_mul_f32 v68, v68, v10
    v_mul_f32 v69, v69, v10
    v_mul_f32 v70, v70, v10
    v_mul_f32 v71, v71, v10
    v_fmac_f32 v64, v72, v11
    v_fmac_f32 v65, v73, v11
    v_fmac_f32 v66, v74, v11
    v_fmac_f32 v67, v75, v11
    v_fmac_f32 v68, v76, v11
    v_fmac_f32 v69, v77, v11
    v_fmac_f32 v70, v78, v11
    v_fmac_f32 v71, v79, v11
    v_cvt_pk_bf16_f32 v40, v64, v65
    v_cvt_pk_bf16_f32 v41, v66, v67
    v_cvt_pk_bf16_f32 v42, v68, v69
    v_cvt_pk_bf16_f32 v43, v70, v71
    ds_write_b64 v4, v[40:41] offset:1056
    ds_write_b64 v4, v[42:43] offset:1088
    v_lshlrev_b32 v10, 3, v50
    v_bfe_i32 v64, v48, 0, 10
    v_bfe_i32 v65, v48, 10, 10
    v_bfe_i32 v66, v48, 20, 10
    v_bfe_i32 v67, v49, 0, 10
    v_bfe_i32 v68, v49, 10, 10
    v_bfe_i32 v69, v49, 20, 10
    v_bfe_i32 v70, v50, 0, 10
    v_bfe_i32 v71, v50, 10, 10
    v_and_b32 v10, 0x7f800000, v10
    v_cvt_f32_i32 v64, v64
    v_cvt_f32_i32 v65, v65
    v_cvt_f32_i32 v66, v66
    v_cvt_f32_i32 v67, v67
    v_cvt_f32_i32 v68, v68
    v_cvt_f32_i32 v69, v69
    v_cvt_f32_i32 v70, v70
    v_cvt_f32_i32 v71, v71
    v_add_u32 v10, 0xfc004020, v10
    v_lshlrev_b32 v11, 3, v54
    v_bfe_i32 v72, v52, 0, 10
    v_bfe_i32 v73, v52, 10, 10
    v_bfe_i32 v74, v52, 20, 10
    v_bfe_i32 v75, v53, 0, 10
    v_bfe_i32 v76, v53, 10, 10
    v_bfe_i32 v77, v53, 20, 10
    v_bfe_i32 v78, v54, 0, 10
    v_bfe_i32 v79, v54, 10, 10
    v_and_b32 v11, 0x7f800000, v11
    v_cvt_f32_i32 v72, v72
    v_cvt_f32_i32 v73, v73
    v_cvt_f32_i32 v74, v74
    v_cvt_f32_i32 v75, v75
    v_cvt_f32_i32 v76, v76
    v_cvt_f32_i32 v77, v77
    v_cvt_f32_i32 v78, v78
    v_cvt_f32_i32 v79, v79
    v_add_u32 v11, 0xfc004020, v11
    v_mul_f32 v64, v64, v10
    v_mul_f32 v65, v65, v10
    v_mul_f32 v66, v66, v10
    v_mul_f32 v67, v67, v10
    v_mul_f32 v68, v68, v10
    v_mul_f32 v69, v69, v10
    v_mul_f32 v70, v70, v10
    v_mul_f32 v71, v71, v10
    v_fmac_f32 v64, v72, v11
    v_fmac_f32 v65, v73, v11
    v_fmac_f32 v66, v74, v11
    v_fmac_f32 v67, v75, v11
    v_fmac_f32 v68, v76, v11
    v_fmac_f32 v69, v77, v11
    v_fmac_f32 v70, v78, v11
    v_fmac_f32 v71, v79, v11
    v_cvt_pk_bf16_f32 v48, v64, v65
    v_cvt_pk_bf16_f32 v49, v66, v67
    v_cvt_pk_bf16_f32 v50, v68, v69
    v_cvt_pk_bf16_f32 v51, v70, v71
    ds_write_b64 v4, v[48:49] offset:2112
    ds_write_b64 v4, v[50:51] offset:2144
    v_lshlrev_b32 v10, 3, v58
    v_bfe_i32 v64, v56, 0, 10
    v_bfe_i32 v65, v56, 10, 10
    v_bfe_i32 v66, v56, 20, 10
    v_bfe_i32 v67, v57, 0, 10
    v_bfe_i32 v68, v57, 10, 10
    v_bfe_i32 v69, v57, 20, 10
    v_bfe_i32 v70, v58, 0, 10
    v_bfe_i32 v71, v58, 10, 10
    v_and_b32 v10, 0x7f800000, v10
    v_cvt_f32_i32 v64, v64
    v_cvt_f32_i32 v65, v65
    v_cvt_f32_i32 v66, v66
    v_cvt_f32_i32 v67, v67
    v_cvt_f32_i32 v68, v68
    v_cvt_f32_i32 v69, v69
    v_cvt_f32_i32 v70, v70
    v_cvt_f32_i32 v71, v71
    v_add_u32 v10, 0xfc004020, v10
    v_lshlrev_b32 v11, 3, v62
    v_bfe_i32 v72, v60, 0, 10
    v_bfe_i32 v73, v60, 10, 10
    v_bfe_i32 v74, v60, 20, 10
    v_bfe_i32 v75, v61, 0, 10
    v_bfe_i32 v76, v61, 10, 10
    v_bfe_i32 v77, v61, 20, 10
    v_bfe_i32 v78, v62, 0, 10
    v_bfe_i32 v79, v62, 10, 10
    v_and_b32 v11, 0x7f800000, v11
    v_cvt_f32_i32 v72, v72
    v_cvt_f32_i32 v73, v73
    v_cvt_f32_i32 v74, v74
    v_cvt_f32_i32 v75, v75
    v_cvt_f32_i32 v76, v76
    v_cvt_f32_i32 v77, v77
    v_cvt_f32_i32 v78, v78
    v_cvt_f32_i32 v79, v79
    v_add_u32 v11, 0xfc004020, v11
    v_mul_f32 v64, v64, v10
    v_mul_f32 v65, v65, v10
    v_mul_f32 v66, v66, v10
    v_mul_f32 v67, v67, v10
    v_mul_f32 v68, v68, v10
    v_mul_f32 v69, v69, v10
    v_mul_f32 v70, v70, v10
    v_mul_f32 v71, v71, v10
    v_fmac_f32 v64, v72, v11
    v_fmac_f32 v65, v73, v11
    v_fmac_f32 v66, v74, v11
    v_fmac_f32 v67, v75, v11
    v_fmac_f32 v68, v76, v11
    v_fmac_f32 v69, v77, v11
    v_fmac_f32 v70, v78, v11
    v_fmac_f32 v71, v79, v11
    v_cvt_pk_bf16_f32 v56, v64, v65
    v_cvt_pk_bf16_f32 v57, v66, v67
    v_cvt_pk_bf16_f32 v58, v68, v69
    v_cvt_pk_bf16_f32 v59, v70, v71
    ds_write_b64 v4, v[56:57] offset:3168
    ds_write_b64 v4, v[58:59] offset:3200
    v_mov_b32 v3, 1
    s_mov_b64 exec, 1
    ds_add_u32 v9, v3 offset:27928
    s_mov_b64 exec, -1
    s_add_u32 s72, s58, s83
    s_add_u32 s72, s72, 4
    s_and_b32 s72, s72, 7
    s_lshl_b32 s72, s72, 4
    s_mul_i32 s80, s72, 1056
    s_lshl_b32 s73, s57, 7
    s_add_u32 s72, s72, s73
    s_lshl_b32 s72, s72, 10
    buffer_load_dwordx4 v[96:99], v8, s[24:27], s72 offen offset:0
    buffer_load_dwordx4 v[100:103], v8, s[24:27], s72 offen offset:1024
    buffer_load_dwordx4 v[104:107], v8, s[24:27], s72 offen offset:2048
    buffer_load_dwordx4 v[108:111], v8, s[24:27], s72 offen offset:3072
    s_add_u32 s72, s72, 4096
    buffer_load_dwordx4 v[112:115], v8, s[24:27], s72 offen offset:0
    buffer_load_dwordx4 v[116:119], v8, s[24:27], s72 offen offset:1024
    buffer_load_dwordx4 v[120:123], v8, s[24:27], s72 offen offset:2048
    buffer_load_dwordx4 v[124:127], v8, s[24:27], s72 offen offset:3072
    s_add_u32 s72, s72, 4096
    buffer_load_dwordx4 v[128:131], v8, s[24:27], s72 offen offset:0
    buffer_load_dwordx4 v[132:135], v8, s[24:27], s72 offen offset:1024
    buffer_load_dwordx4 v[136:139], v8, s[24:27], s72 offen offset:2048
    buffer_load_dwordx4 v[140:143], v8, s[24:27], s72 offen offset:3072
    s_add_u32 s72, s72, 4096
    buffer_load_dwordx4 v[144:147], v8, s[24:27], s72 offen offset:0
    buffer_load_dwordx4 v[148:151], v8, s[24:27], s72 offen offset:1024
    buffer_load_dwordx4 v[152:155], v8, s[24:27], s72 offen offset:2048
    buffer_load_dwordx4 v[156:159], v8, s[24:27], s72 offen offset:3072
L_cw_20:
    ds_read_b32 v3, v9 offset:27948
    s_add_u32 s82, s82, 1
    s_cmp_gt_u32 s82, 0x60000000
    s_cbranch_scc1 L_cwok_21
    s_waitcnt lgkmcnt(0)
    v_readfirstlane_b32 s100, v3
    s_cmp_ge_u32 s100, 4
    s_cbranch_scc0 L_cw_20
L_cwok_21:
    s_waitcnt lgkmcnt(0)
    ds_read_b128 v[32:35], v5 offset:0
    ds_read_b128 v[36:39], v5 offset:64
    ds_read_b128 v[40:43], v5 offset:128
    ds_read_b128 v[44:47], v5 offset:192
    ds_read_b128 v[48:51], v5 offset:256
    ds_read_b128 v[52:55], v5 offset:320
    ds_read_b128 v[56:59], v5 offset:384
    ds_read_b128 v[60:63], v5 offset:448
    ds_read_b128 v[64:67], v5 offset:512
    ds_read_b128 v[68:71], v5 offset:576
    ds_read_b128 v[72:75], v5 offset:640
    ds_read_b128 v[76:79], v5 offset:704
    ds_read_b128 v[80:83], v5 offset:768
    ds_read_b128 v[84:87], v5 offset:832
    ds_read_b128 v[88:91], v5 offset:896
    ds_read_b128 v[92:95], v5 offset:960
    ds_read_b64_tr_b16 v[160:161], v6 offset:0
    ds_read_b64_tr_b16 v[162:163], v6 offset:16896
    ds_read_b64_tr_b16 v[176:177], v6 offset:32
    ds_read_b64_tr_b16 v[178:179], v6 offset:16928
    ds_read_b64_tr_b16 v[192:193], v6 offset:64
    ds_read_b64_tr_b16 v[194:195], v6 offset:16960
    ds_read_b64_tr_b16 v[208:209], v6 offset:96
    ds_read_b64_tr_b16 v[210:211], v6 offset:16992
    ds_read_b64_tr_b16 v[164:165], v6 offset:33792
    ds_read_b64_tr_b16 v[166:167], v6 offset:50688
    ds_read_b64_tr_b16 v[180:181], v6 offset:33824
    ds_read_b64_tr_b16 v[182:183], v6 offset:50720
    ds_read_b64_tr_b16 v[196:197], v6 offset:33856
    ds_read_b64_tr_b16 v[198:199], v6 offset:50752
    ds_read_b64_tr_b16 v[212:213], v6 offset:33888
    ds_read_b64_tr_b16 v[214:215], v6 offset:50784
    ds_read_b64_tr_b16 v[168:169], v7 offset:0
    ds_read_b64_tr_b16 v[170:171], v7 offset:16896
    ds_read_b64_tr_b16 v[184:185], v7 offset:32
    ds_read_b64_tr_b16 v[186:187], v7 offset:16928
    ds_read_b64_tr_b16 v[200:201], v7 offset:64
    ds_read_b64_tr_b16 v[202:203], v7 offset:16960
    ds_read_b64_tr_b16 v[216:217], v7 offset:96
    ds_read_b64_tr_b16 v[218:219], v7 offset:16992
    ds_read_b64_tr_b16 v[172:173], v7 offset:33792
    ds_read_b64_tr_b16 v[174:175], v7 offset:50688
    ds_read_b64_tr_b16 v[188:189], v7 offset:33824
    ds_read_b64_tr_b16 v[190:191], v7 offset:50720
    ds_read_b64_tr_b16 v[204:205], v7 offset:33856
    ds_read_b64_tr_b16 v[206:207], v7 offset:50752
    ds_read_b64_tr_b16 v[220:221], v7 offset:33888
    ds_read_b64_tr_b16 v[222:223], v7 offset:50784
    s_waitcnt lgkmcnt(0)
L_cw_22:
    ds_read_b32 v3, v9 offset:27928
    s_add_u32 s82, s82, 1
    s_cmp_gt_u32 s82, 0x60000000
    s_cbranch_scc1 L_cwok_23
    s_waitcnt lgkmcnt(0)
    v_readfirstlane_b32 s100, v3
    s_cmp_ge_u32 s100, 4
    s_cbranch_scc0 L_cw_22
L_cwok_23:
    s_waitcnt lgkmcnt(0)
    v_mul_u32_u24 v10, 1056, v1
    v_lshl_add_u32 v10, v2, 4, v10
    ds_read_b128 v[228:231], v10 offset:0
    ds_read_b128 v[232:235], v10 offset:64
    ds_read_b128 v[236:239], v10 offset:128
    ds_read_b128 v[240:243], v10 offset:192
    ds_read_b128 v[244:247], v10 offset:256
    v_lshlrev_b32 v4, 5, v1
    s_lshl_b32 s72, s56, 2
    v_add_u32 v11, s72, v4
    s_waitcnt lgkmcnt(4)
    v_mfma_f32_16x16x32_bf16 v[224:227], v[32:35], v[228:231], 0
    ds_read_b128 v[228:231], v10 offset:320
    s_waitcnt lgkmcnt(4)
    v_mfma_f32_16x16x32_bf16 v[224:227], v[36:39], v[232:235], v[224:227]
    ds_read_b128 v[232:235], v10 offset:384
    s_waitcnt lgkmcnt(4)
    v_mfma_f32_16x16x32_bf16 v[224:227], v[40:43], v[236:239], v[224:227]
    ds_read_b128 v[236:239], v10 offset:448
    s_waitcnt lgkmcnt(4)
    v_mfma_f32_16x16x32_bf16 v[224:227], v[44:47], v[240:243], v[224:227]
    ds_read_b128 v[240:243], v10 offset:512
    s_waitcnt lgkmcnt(4)
    v_mfma_f32_16x16x32_bf16 v[224:227], v[48:51], v[244:247], v[224:227]
    ds_read_b128 v[244:247], v10 offset:576
    s_waitcnt lgkmcnt(4)
    v_mfma_f32_16x16x32_bf16 v[224:227], v[52:55], v[228:231], v[224:227]
    ds_read_b128 v[228:231], v10 offset:640
    s_waitcnt lgkmcnt(4)
    v_mfma_f32_16x16x32_bf16 v[224:227], v[56:59], v[232:235], v[224:227]
    ds_read_b128 v[232:235], v10 offset:704
    s_waitcnt lgkmcnt(4)
    v_mfma_f32_16x16x32_bf16 v[224:227], v[60:63], v[236:239], v[224:227]
    ds_read_b128 v[236:239], v10 offset:768
    s_waitcnt lgkmcnt(4)
    v_mfma_f32_16x16x32_bf16 v[224:227], v[64:67], v[240:243], v[224:227]
    ds_read_b128 v[240:243], v10 offset:832
    s_waitcnt lgkmcnt(4)
    v_mfma_f32_16x16x32_bf16 v[224:227], v[68:71], v[244:247], v[224:227]
    ds_read_b128 v[244:247], v10 offset:896
    s_waitcnt lgkmcnt(4)
    v_mfma_f32_16x16x32_bf16 v[224:227], v[72:75], v[228:231], v[224:227]
    ds_read_b128 v[228:231], v10 offset:960
    s_waitcnt lgkmcnt(4)
    v_mfma_f32_16x16x32_bf16 v[224:227], v[76:79], v[232:235], v[224:227]
    s_waitcnt lgkmcnt(3)
    v_mfma_f32_16x16x32_bf16 v[224:227], v[80:83], v[236:239], v[224:227]
    s_waitcnt lgkmcnt(2)
    v_mfma_f32_16x16x32_bf16 v[224:227], v[84:87], v[240:243], v[224:227]
    s_waitcnt lgkmcnt(1)
    v_mfma_f32_16x16x32_bf16 v[224:227], v[88:91], v[244:247], v[224:227]
    s_waitcnt lgkmcnt(0)
    v_mfma_f32_16x16x32_bf16 v[224:227], v[92:95], v[228:231], v[224:227]
    s_lshr_b32 s72, s56, 1
    s_lshl_b32 s72, s72, 10
    s_and_b32 s73, s56, 1
    s_lshl_b32 s73, s73, 3
    s_add_u32 s72, s72, s73
    v_add_u32 v10, s72, v8
    s_nop 1
    v_max3_f32 v5, v224, v225, v226
    v_max_f32 v5, v5, v227
    v_mov_b32 v3, v5
    s_nop 1
    v_permlane16_swap_b32 v5, v3
    v_max_f32 v5, v5, v3
    v_mov_b32 v3, v5
    s_nop 1
    v_permlane32_swap_b32 v5, v3
    v_max_f32 v5, v5, v3
    ds_write_b32 v11, v5 offset:26624
    s_waitcnt lgkmcnt(0)
    s_barrier
    ds_read_b128 v[232:235], v4 offset:26624
    ds_read_b128 v[236:239], v4 offset:26640
    v_mul_u32_u24 v3, 3584, v0
    s_mul_i32 s72, s56, 229376
    s_lshl_b32 s73, s63, 1
    s_add_u32 s72, s72, s73
    s_lshl_b32 s73, s56, 10
    s_add_u32 s73, s73, 8448
    s_mov_b32 m0, s73
    s_add_u32 s73, s63, s56
    buffer_load_dwordx4 v3, s[28:31], s72 offen lds
    s_lshl_b32 s73, s73, 10
    s_mul_i32 s72, s56, 1056
    s_mov_b32 m0, s72
    s_nop 0
    buffer_load_dwordx4 v8, s[36:39], s73 offen lds
    s_waitcnt lgkmcnt(0)
    v_max3_f32 v5, v232, v233, v234
    v_max3_f32 v3, v235, v236, v237
    v_max3_f32 v5, v5, v238, v239
    v_max_f32 v5, v5, v3
    v_mul_f32 v5, s71, v5
    v_fma_f32 v224, v224, s71, -v5
    v_fma_f32 v225, v225, s71, -v5
    v_fma_f32 v226, v226, s71, -v5
    v_fma_f32 v227, v227, s71, -v5
    v_exp_f32 v224, v224
    v_exp_f32 v225, v225
    v_exp_f32 v226, v226
    v_exp_f32 v227, v227
    s_nop 0
    v_pk_add_f32 v[232:233], v[224:225], v[226:227]
    v_cvt_pk_bf16_f32 v224, v224, v225
    v_cvt_pk_bf16_f32 v225, v226, v227
    ds_write_b64 v10, v[224:225] offset:22528
    v_add_f32 v232, v232, v233
    v_mov_b32 v233, v232
    s_nop 1
    v_permlane16_swap_b32 v232, v233
    v_add_f32 v232, v232, v233
    v_mov_b32 v233, v232
    s_nop 1
    v_permlane32_swap_b32 v232, v233
    v_add_f32 v232, v232, v233
    ds_write_b32 v11, v232 offset:27136
    v_and_b32 v4, 7, v1
    v_mul_u32_u24 v4, 131072, v4
    v_lshl_add_u32 v4, v2, 4, v4
    v_lshrrev_b32 v3, 3, v1
    v_lshl_add_u32 v4, v3, 6, v4
    s_mov_b32 vcc_lo, 0xff00ff00
    s_mov_b32 vcc_hi, 0xff00ff00
    s_mul_i32 s72, s61, 2097152
    s_mul_i32 s73, s56, 16384
    s_add_u32 s72, s72, s73
    s_lshl_b32 s73, s59, 12
    s_add_u32 s72, s72, s73
    s_lshl_b32 s73, s60, 7
    s_add_u32 s72, s72, s73
    s_add_u32 s72, s72, 1048576
    s_add_u32 s74, s72, 1048576
    s_waitcnt lgkmcnt(0)
    s_barrier
    ds_read_b128 v[224:227], v8 offset:22528
    ds_read_b128 v[228:231], v8 offset:23552
    ds_read_b128 v[232:235], v8 offset:24576
    ds_read_b128 v[236:239], v8 offset:25600
    s_waitcnt lgkmcnt(3)
    v_mfma_f32_16x16x32_bf16 v[32:35], v[160:163], v[224:227], 0
    v_mfma_f32_16x16x32_bf16 v[36:39], v[176:179], v[224:227], 0
    s_waitcnt lgkmcnt(2)
    v_mfma_f32_16x16x32_bf16 v[32:35], v[164:167], v[228:231], v[32:35]
    v_mfma_f32_16x16x32_bf16 v[36:39], v[180:183], v[228:231], v[36:39]
    s_waitcnt lgkmcnt(1)
    v_mfma_f32_16x16x32_bf16 v[32:35], v[168:171], v[232:235], v[32:35]
    v_mfma_f32_16x16x32_bf16 v[36:39], v[184:187], v[232:235], v[36:39]
    s_waitcnt lgkmcnt(0)
    v_mfma_f32_16x16x32_bf16 v[32:35], v[172:175], v[236:239], v[32:35]
    v_mfma_f32_16x16x32_bf16 v[36:39], v[188:191], v[236:239], v[36:39]
    v_mfma_f32_16x16x32_bf16 v[40:43], v[192:195], v[224:227], 0
    v_mfma_f32_16x16x32_bf16 v[44:47], v[208:211], v[224:227], 0
    v_mfma_f32_16x16x32_bf16 v[40:43], v[196:199], v[228:231], v[40:43]
    v_mfma_f32_16x16x32_bf16 v[44:47], v[212:215], v[228:231], v[44:47]
    v_mfma_f32_16x16x32_bf16 v[40:43], v[200:203], v[232:235], v[40:43]
    v_mfma_f32_16x16x32_bf16 v[44:47], v[216:219], v[232:235], v[44:47]
    v_mfma_f32_16x16x32_bf16 v[40:43], v[204:207], v[236:239], v[40:43]
    v_mfma_f32_16x16x32_bf16 v[44:47], v[220:223], v[236:239], v[44:47]
    v_max3_f32 v6, |v32|, |v33|, |v34|
    v_max3_f32 v7, |v35|, |v36|, |v37|
    v_max3_f32 v6, |v38|, |v39|, v6
    v_max_f32 v6, v6, v7
    v_and_b32 v6, 0x7f800000, v6
    v_max_u32 v6, 0x08000000, v6
    v_sub_u32 v7, 0x82ff8000, v6
    v_fma_f32 v32, v32, v7, s91
    v_fma_f32 v33, v33, v7, s91
    v_fma_f32 v34, v34, v7, s91
    v_fma_f32 v35, v35, v7, s91
    v_fma_f32 v36, v36, v7, s91
    v_fma_f32 v37, v37, v7, s91
    v_fma_f32 v38, v38, v7, s91
    v_fma_f32 v39, v39, v7, s91
    v_lshrrev_b32 v6, 3, v6
    v_lshlrev_b32 v33, 10, v33
    v_lshlrev_b32 v36, 10, v36
    v_lshlrev_b32 v39, 10, v39
    v_lshlrev_b32 v34, 20, v34
    v_lshlrev_b32 v37, 20, v37
    v_or_b32 v6, v6, v252
    v_bfi_b32 v32, s88, v32, v250
    v_bfi_b32 v35, s88, v35, v251
    v_bfi_b32 v38, s88, v38, v6
    v_bfi_b32 v32, s89, v33, v32
    v_bfi_b32 v35, s89, v36, v35
    v_bfi_b32 v50, s89, v39, v38
    v_bfi_b32 v48, s90, v34, v32
    v_bfi_b32 v49, s90, v37, v35
    v_mov_b32 v51, v253
    v_max3_f32 v6, |v40|, |v41|, |v42|
    v_max3_f32 v7, |v43|, |v44|, |v45|
    v_max3_f32 v6, |v46|, |v47|, v6
    v_max_f32 v6, v6, v7
    v_and_b32 v6, 0x7f800000, v6
    v_max_u32 v6, 0x08000000, v6
    v_sub_u32 v7, 0x82ff8000, v6
    v_fma_f32 v40, v40, v7, s91
    v_fma_f32 v41, v41, v7, s91
    v_fma_f32 v42, v42, v7, s91
    v_fma_f32 v43, v43, v7, s91
    v_fma_f32 v44, v44, v7, s91
    v_fma_f32 v45, v45, v7, s91
    v_fma_f32 v46, v46, v7, s91
    v_fma_f32 v47, v47, v7, s91
    v_lshrrev_b32 v6, 3, v6
    v_lshlrev_b32 v41, 10, v41
    v_lshlrev_b32 v44, 10, v44
    v_lshlrev_b32 v47, 10, v47
    v_lshlrev_b32 v42, 20, v42
    v_lshlrev_b32 v45, 20, v45
    v_or_b32 v6, v6, v252
    v_bfi_b32 v40, s88, v40, v250
    v_bfi_b32 v43, s88, v43, v251
    v_bfi_b32 v46, s88, v46, v6
    v_bfi_b32 v40, s89, v41, v40
    v_bfi_b32 v43, s89, v44, v43
    v_bfi_b32 v54, s89, v47, v46
    v_bfi_b32 v52, s90, v42, v40
    v_bfi_b32 v53, s90, v45, v43
    v_mov_b32 v55, v253
    v_cndmask_b32 v56, v52, v48, vcc
    v_cndmask_b32 v57, v53, v49, vcc
    v_cndmask_b32 v58, v54, v50, vcc
    s_nop 0
    v_mov_b32 v60, v56 row_ror:8
    v_mov_b32 v61, v57 row_ror:8
    v_mov_b32 v62, v58 row_ror:8
    v_cndmask_b32 v48, v48, v60, vcc
    v_cndmask_b32 v49, v49, v61, vcc
    v_cndmask_b32 v50, v50, v62, vcc
    buffer_store_dwordx4 v[48:51], v4, s[52:55], s72 offen sc1
    v_cndmask_b32 v52, v60, v52, vcc
    v_cndmask_b32 v53, v61, v53, vcc
    v_cndmask_b32 v54, v62, v54, vcc
    buffer_store_dwordx4 v[52:55], v4, s[52:55], s74 offen sc1
    s_add_u32 s80, s80, 28672
    v_add_u32 v3, s80, v8
    s_waitcnt vmcnt(4)
    ds_write_b128 v3, v[96:99] offset:0
    ds_write_b128 v3, v[100:103] offset:1056
    ds_write_b128 v3, v[104:107] offset:2112
    ds_write_b128 v3, v[108:111] offset:3168
    ds_write_b128 v3, v[112:115] offset:4224
    ds_write_b128 v3, v[116:119] offset:5280
    ds_write_b128 v3, v[120:123] offset:6336
    ds_write_b128 v3, v[124:127] offset:7392
    ds_write_b128 v3, v[128:131] offset:8448
    ds_write_b128 v3, v[132:135] offset:9504
    ds_write_b128 v3, v[136:139] offset:10560
    ds_write_b128 v3, v[140:143] offset:11616
    ds_write_b128 v3, v[144:147] offset:12672
    ds_write_b128 v3, v[148:151] offset:13728
    ds_write_b128 v3, v[152:155] offset:14784
    ds_write_b128 v3, v[156:159] offset:15840
    s_lshl_b32 s75, s57, 3
    s_add_u32 s75, s75, s58
    s_mul_i32 s75, s75, 16384
    s_lshl_b32 s72, s56, 12
    s_add_u32 s75, s75, s72
    s_add_u32 s75, s75, 1048576
    v_and_b32 v10, 31, v0
    v_lshlrev_b32 v10, 4, v10
    s_lshl_b32 s74, s57, 2
    s_add_u32 s74, s74, s56
    s_lshl_b32 s74, s74, 9
    s_add_u32 s74, s74, 9437184
    v_lshrrev_b32 v5, 2, v1
    v_lshl_add_u32 v6, v2, 3, v5
    v_mul_u32_u24 v6, 1056, v6
    v_mul_u32_u24 v5, 1056, v5
    v_and_b32 v7, 3, v1
    v_lshlrev_b32 v7, 3, v7
    s_lshl_b32 s72, s56, 7
    v_add_u32 v7, s72, v7
    v_add_u32 v5, v5, v7
    v_add_u32 v6, v6, v7
    v_add_u32 v6, 28672, v6
    v_add_u32 v7, 67584, v6
    s_waitcnt vmcnt(2)
    v_mov_b32 v3, 1
    s_mov_b64 exec, 1
    ds_add_u32 v9, v3 offset:27956
    s_mov_b64 exec, -1
    s_sleep 24
    buffer_load_dwordx4 v[176:179], v8, s[52:55], s75 offen offset:0 sc1
    buffer_load_dwordx4 v[180:183], v8, s[52:55], s75 offen offset:1024 sc1
    buffer_load_dwordx4 v[184:187], v8, s[52:55], s75 offen offset:2048 sc1
    buffer_load_dwordx4 v[188:191], v8, s[52:55], s75 offen offset:3072 sc1
    buffer_load_dwordx4 v[192:195], v10, s[52:55], s74 offen sc1
    s_mov_b32 s101, 31
    s_waitcnt vmcnt(0)
L_g_24:
    s_bitcmp1_b32 s101, 0
    s_cbranch_scc0 L_gs_26
    v_xor_b32 v3, s84, v176
    v_xor_b32 v4, s85, v177
    v_or_b32 v3, v3, v4
    v_xor_b32 v4, s86, v178
    v_lshrrev_b32 v3, 30, v3
    v_lshrrev_b32 v4, 28, v4
    v_xor_b32 v179, s87, v179
    v_or3_b32 v3, v3, v4, v179
    v_cmp_ne_u32 vcc, 0, v3
    s_bitset0_b32 s101, 0
    s_cbranch_vccz L_gs_26
    s_bitset1_b32 s101, 0
    buffer_load_dwordx4 v[176:179], v8, s[52:55], s75 offen offset:0 sc1
L_gs_26:
    s_bitcmp1_b32 s101, 1
    s_cbranch_scc0 L_gs_27
    v_xor_b32 v3, s84, v180
    v_xor_b32 v4, s85, v181
    v_or_b32 v3, v3, v4
    v_xor_b32 v4, s86, v182
    v_lshrrev_b32 v3, 30, v3
    v_lshrrev_b32 v4, 28, v4
    v_xor_b32 v183, s87, v183
    v_or3_b32 v3, v3, v4, v183
    v_cmp_ne_u32 vcc, 0, v3
    s_bitset0_b32 s101, 1
    s_cbranch_vccz L_gs_27
    s_bitset1_b32 s101, 1
    buffer_load_dwordx4 v[180:183], v8, s[52:55], s75 offen offset:1024 sc1
L_gs_27:
    s_bitcmp1_b32 s101, 2
    s_cbranch_scc0 L_gs_28
    v_xor_b32 v3, s84, v184
    v_xor_b32 v4, s85, v185
    v_or_b32 v3, v3, v4
    v_xor_b32 v4, s86, v186
    v_lshrrev_b32 v3, 30, v3
    v_lshrrev_b32 v4, 28, v4
    v_xor_b32 v187, s87, v187
    v_or3_b32 v3, v3, v4, v187
    v_cmp_ne_u32 vcc, 0, v3
    s_bitset0_b32 s101, 2
    s_cbranch_vccz L_gs_28
    s_bitset1_b32 s101, 2
    buffer_load_dwordx4 v[184:187], v8, s[52:55], s75 offen offset:2048 sc1
L_gs_28:
    s_bitcmp1_b32 s101, 3
    s_cbranch_scc0 L_gs_29
    v_xor_b32 v3, s84, v188
    v_xor_b32 v4, s85, v189
    v_or_b32 v3, v3, v4
    v_xor_b32 v4, s86, v190
    v_lshrrev_b32 v3, 30, v3
    v_lshrrev_b32 v4, 28, v4
    v_xor_b32 v191, s87, v191
    v_or3_b32 v3, v3, v4, v191
    v_cmp_ne_u32 vcc, 0, v3
    s_bitset0_b32 s101, 3
    s_cbranch_vccz L_gs_29
    s_bitset1_b32 s101, 3
    buffer_load_dwordx4 v[188:191], v8, s[52:55], s75 offen offset:3072 sc1
L_gs_29:
    s_bitcmp1_b32 s101, 4
    s_cbranch_scc0 L_gs_30
    v_xor_b32 v192, s64, v192
    v_xor_b32 v193, s65, v193
    v_xor_b32 v194, s66, v194
    v_xor_b32 v195, s67, v195
    v_or3_b32 v3, v192, v193, v194
    v_or_b32 v3, v3, v195
    v_and_b32 v3, 0xfff, v3
    v_cmp_ne_u32 vcc, 0, v3
    s_bitset0_b32 s101, 4
    s_cbranch_vccz L_gs_30
    s_bitset1_b32 s101, 4
    buffer_load_dwordx4 v[192:195], v10, s[52:55], s74 offen sc1
L_gs_30:
    s_cmp_eq_u32 s101, 0
    s_cbranch_scc1 L_gdone_25
    s_add_u32 s82, s82, 0x10000
    s_cmp_gt_u32 s82, 0x40000000
    s_cbranch_scc1 L_gdone_25
    s_waitcnt vmcnt(0)
    s_branch L_g_24
L_gdone_25:
L_cw_31:
    ds_read_b32 v3, v9 offset:27956
    s_add_u32 s82, s82, 1
    s_cmp_gt_u32 s82, 0x60000000
    s_cbranch_scc1 L_cwok_32
    s_waitcnt lgkmcnt(0)
    v_readfirstlane_b32 s100, v3
    s_cmp_ge_u32 s100, 8
    s_cbranch_scc0 L_cw_31
L_cwok_32:
    s_waitcnt lgkmcnt(0)
    ds_read_b64_tr_b16 v[160:161], v5 offset:0
    ds_read_b64_tr_b16 v[162:163], v5 offset:4224
    ds_read_b64_tr_b16 v[164:165], v5 offset:32
    ds_read_b64_tr_b16 v[166:167], v5 offset:4256
    ds_read_b64_tr_b16 v[168:169], v5 offset:64
    ds_read_b64_tr_b16 v[170:171], v5 offset:4288
    ds_read_b64_tr_b16 v[172:173], v5 offset:96
    ds_read_b64_tr_b16 v[174:175], v5 offset:4320
    ds_read_b64_tr_b16 v[32:33], v6 offset:0
    ds_read_b64_tr_b16 v[34:35], v6 offset:4224
    ds_read_b64_tr_b16 v[48:49], v6 offset:32
    ds_read_b64_tr_b16 v[50:51], v6 offset:4256
    ds_read_b64_tr_b16 v[64:65], v6 offset:64
    ds_read_b64_tr_b16 v[66:67], v6 offset:4288
    ds_read_b64_tr_b16 v[80:81], v6 offset:96
    ds_read_b64_tr_b16 v[82:83], v6 offset:4320
    ds_read_b64_tr_b16 v[36:37], v6 offset:33792
    ds_read_b64_tr_b16 v[38:39], v6 offset:38016
    ds_read_b64_tr_b16 v[52:53], v6 offset:33824
    ds_read_b64_tr_b16 v[54:55], v6 offset:38048
    ds_read_b64_tr_b16 v[68:69], v6 offset:33856
    ds_read_b64_tr_b16 v[70:71], v6 offset:38080
    ds_read_b64_tr_b16 v[84:85], v6 offset:33888
    ds_read_b64_tr_b16 v[86:87], v6 offset:38112
    ds_read_b64_tr_b16 v[40:41], v7 offset:0
    ds_read_b64_tr_b16 v[42:43], v7 offset:4224
    ds_read_b64_tr_b16 v[56:57], v7 offset:32
    ds_read_b64_tr_b16 v[58:59], v7 offset:4256
    ds_read_b64_tr_b16 v[72:73], v7 offset:64
    ds_read_b64_tr_b16 v[74:75], v7 offset:4288
    ds_read_b64_tr_b16 v[88:89], v7 offset:96
    ds_read_b64_tr_b16 v[90:91], v7 offset:4320
    ds_read_b64_tr_b16 v[44:45], v7 offset:33792
    ds_read_b64_tr_b16 v[46:47], v7 offset:38016
    ds_read_b64_tr_b16 v[60:61], v7 offset:33824
    ds_read_b64_tr_b16 v[62:63], v7 offset:38048
    ds_read_b64_tr_b16 v[76:77], v7 offset:33856
    ds_read_b64_tr_b16 v[78:79], v7 offset:38080
    ds_read_b64_tr_b16 v[92:93], v7 offset:33888
    ds_read_b64_tr_b16 v[94:95], v7 offset:38112
    v_lshrrev_b32 v194, 20, v194
    v_lshrrev_b32 v195, 20, v195
    v_or_b32 v192, v192, v194
    v_or_b32 v193, v193, v195
    v_mov_b32 v5, v192
    s_nop 1
    v_max_f32 v5, v5, v5 row_ror:1
    s_nop 1
    v_max_f32 v5, v5, v5 row_ror:2
    s_nop 1
    v_max_f32 v5, v5, v5 row_ror:4
    s_nop 1
    v_max_f32 v5, v5, v5 row_ror:8
    v_mov_b32 v6, v5
    s_nop 1
    v_permlane16_swap_b32 v5, v6
    v_max_f32 v5, v5, v6
    v_sub_f32 v192, v192, v5
    v_exp_f32 v192, v192
    v_and_b32 v6, 7, v0
    v_mul_f32 v5, v192, v193
    v_lshlrev_b32 v6, 4, v6
    v_bfe_u32 v7, v0, 3, 2
    v_add_f32 v5, v5, v5 row_ror:1
    v_lshl_add_u32 v6, v7, 2, v6
    s_lshl_b32 s72, s56, 7
    v_add_f32 v5, v5, v5 row_ror:2
    v_add_u32 v6, s72, v6
    v_lshrrev_b32 v7, 3, v0
    v_add_f32 v5, v5, v5 row_ror:4
    v_lshlrev_b32 v7, 4, v7
    v_add_u32 v7, s72, v7
    v_add_f32 v5, v5, v5 row_ror:8
    v_mov_b32 v4, v5
    s_nop 1
    v_permlane16_swap_b32 v5, v4
    v_add_f32 v5, v5, v4
    v_rcp_f32 v5, v5
    s_nop 0
    v_mul_f32 v5, v5, v192
    ds_write_b32 v6, v5 offset:24064
    ds_read_b128 v[196:199], v7 offset:24064
    v_bfe_u32 v6, v0, 2, 1
    v_lshlrev_b32 v6, 6, v6
    v_and_b32 v7, 3, v0
    v_lshl_add_u32 v6, v7, 3, v6
    v_and_b32 v7, 1, v2
    v_lshl_add_u32 v6, v7, 2, v6
    v_lshrrev_b32 v7, 1, v2
    v_lshl_add_u32 v6, v7, 1, v6
    v_add_u32 v6, s72, v6
    v_lshlrev_b32 v5, 3, v178
    v_bfe_i32 v208, v176, 0, 10
    v_bfe_i32 v209, v176, 10, 10
    v_bfe_i32 v210, v176, 20, 10
    v_bfe_i32 v211, v177, 0, 10
    v_bfe_i32 v212, v177, 10, 10
    v_bfe_i32 v213, v177, 20, 10
    v_bfe_i32 v214, v178, 0, 10
    v_bfe_i32 v215, v178, 10, 10
    v_and_b32 v5, 0x7f800000, v5
    v_cvt_f32_i32 v208, v208
    v_cvt_f32_i32 v209, v209
    v_cvt_f32_i32 v210, v210
    v_cvt_f32_i32 v211, v211
    v_cvt_f32_i32 v212, v212
    v_cvt_f32_i32 v213, v213
    v_cvt_f32_i32 v214, v214
    v_cvt_f32_i32 v215, v215
    v_add_u32 v5, 0xfc004020, v5
    s_waitcnt lgkmcnt(0)
    v_mul_f32 v5, v5, v196
    v_mul_f32 v200, v208, v5
    v_mul_f32 v201, v209, v5
    v_mul_f32 v202, v210, v5
    v_mul_f32 v203, v211, v5
    v_mul_f32 v204, v212, v5
    v_mul_f32 v205, v213, v5
    v_mul_f32 v206, v214, v5
    v_mul_f32 v207, v215, v5
    v_lshlrev_b32 v5, 3, v182
    v_bfe_i32 v208, v180, 0, 10
    v_bfe_i32 v209, v180, 10, 10
    v_bfe_i32 v210, v180, 20, 10
    v_bfe_i32 v211, v181, 0, 10
    v_bfe_i32 v212, v181, 10, 10
    v_bfe_i32 v213, v181, 20, 10
    v_bfe_i32 v214, v182, 0, 10
    v_bfe_i32 v215, v182, 10, 10
    v_and_b32 v5, 0x7f800000, v5
    v_cvt_f32_i32 v208, v208
    v_cvt_f32_i32 v209, v209
    v_cvt_f32_i32 v210, v210
    v_cvt_f32_i32 v211, v211
    v_cvt_f32_i32 v212, v212
    v_cvt_f32_i32 v213, v213
    v_cvt_f32_i32 v214, v214
    v_cvt_f32_i32 v215, v215
    v_add_u32 v5, 0xfc004020, v5
    v_mul_f32 v5, v5, v197
    v_fmac_f32 v200, v208, v5
    v_fmac_f32 v201, v209, v5
    v_fmac_f32 v202, v210, v5
    v_fmac_f32 v203, v211, v5
    v_fmac_f32 v204, v212, v5
    v_fmac_f32 v205, v213, v5
    v_fmac_f32 v206, v214, v5
    v_fmac_f32 v207, v215, v5
    v_lshlrev_b32 v5, 3, v186
    v_bfe_i32 v208, v184, 0, 10
    v_bfe_i32 v209, v184, 10, 10
    v_bfe_i32 v210, v184, 20, 10
    v_bfe_i32 v211, v185, 0, 10
    v_bfe_i32 v212, v185, 10, 10
    v_bfe_i32 v213, v185, 20, 10
    v_bfe_i32 v214, v186, 0, 10
    v_bfe_i32 v215, v186, 10, 10
    v_and_b32 v5, 0x7f800000, v5
    v_cvt_f32_i32 v208, v208
    v_cvt_f32_i32 v209, v209
    v_cvt_f32_i32 v210, v210
    v_cvt_f32_i32 v211, v211
    v_cvt_f32_i32 v212, v212
    v_cvt_f32_i32 v213, v213
    v_cvt_f32_i32 v214, v214
    v_cvt_f32_i32 v215, v215
    v_add_u32 v5, 0xfc004020, v5
    v_mul_f32 v5, v5, v198
    v_fmac_f32 v200, v208, v5
    v_fmac_f32 v201, v209, v5
    v_fmac_f32 v202, v210, v5
    v_fmac_f32 v203, v211, v5
    v_fmac_f32 v204, v212, v5
    v_fmac_f32 v205, v213, v5
    v_fmac_f32 v206, v214, v5
    v_fmac_f32 v207, v215, v5
    v_lshlrev_b32 v5, 3, v190
    v_bfe_i32 v208, v188, 0, 10
    v_bfe_i32 v209, v188, 10, 10
    v_bfe_i32 v210, v188, 20, 10
    v_bfe_i32 v211, v189, 0, 10
    v_bfe_i32 v212, v189, 10, 10
    v_bfe_i32 v213, v189, 20, 10
    v_bfe_i32 v214, v190, 0, 10
    v_bfe_i32 v215, v190, 10, 10
    v_and_b32 v5, 0x7f800000, v5
    v_cvt_f32_i32 v208, v208
    v_cvt_f32_i32 v209, v209
    v_cvt_f32_i32 v210, v210
    v_cvt_f32_i32 v211, v211
    v_cvt_f32_i32 v212, v212
    v_cvt_f32_i32 v213, v213
    v_cvt_f32_i32 v214, v214
    v_cvt_f32_i32 v215, v215
    v_add_u32 v5, 0xfc004020, v5
    v_mul_f32 v5, v5, v199
    v_fmac_f32 v200, v208, v5
    v_fmac_f32 v201, v209, v5
    v_fmac_f32 v202, v210, v5
    v_fmac_f32 v203, v211, v5
    v_fmac_f32 v204, v212, v5
    v_fmac_f32 v205, v213, v5
    v_fmac_f32 v206, v214, v5
    v_fmac_f32 v207, v215, v5
    s_nop 0
    v_permlane32_swap_b32 v200, v201
    v_permlane32_swap_b32 v202, v203
    v_permlane32_swap_b32 v204, v205
    v_permlane32_swap_b32 v206, v207
    v_add_f32 v200, v200, v201
    v_add_f32 v202, v202, v203
    v_add_f32 v204, v204, v205
    v_add_f32 v206, v206, v207
    s_nop 0
    v_permlane16_swap_b32 v200, v202
    v_permlane16_swap_b32 v204, v206
    v_add_f32 v200, v200, v202
    v_add_f32 v204, v204, v206
    s_nop 0
    v_add_f32 v200, v200, v200 row_ror:8
    v_add_f32 v204, v204, v204 row_ror:8
    v_cvt_pk_bf16_f32 v200, v200, v204
    ds_write_b16 v6, v200 offset:22528
    ds_write_b16_d16_hi v6, v200 offset:22560
    v_and_b32 v6, 3, v1
    v_lshlrev_b32 v7, 8, v6
    v_lshl_add_u32 v7, v2, 4, v7
    v_lshlrev_b32 v6, 11, v6
    v_lshl_add_u32 v6, v2, 4, v6
    v_lshrrev_b32 v5, 2, v1
    v_lshl_add_u32 v6, v5, 6, v6
    s_mul_i32 s72, s2, 8320
    s_lshl_b32 s73, s56, 8
    s_add_u32 s72, s72, s73
    s_add_u32 s72, s72, 10485760
    v_cmp_eq_u32 s[80:81], 1, v5
    v_cmp_eq_u32 s[76:77], 2, v5
    v_cmp_eq_u32 s[78:79], 3, v5
    s_waitcnt lgkmcnt(0)
    s_barrier
    v_and_b32 v3, 3, v1
    v_lshlrev_b32 v3, 6, v3
    v_lshl_add_u32 v3, v2, 4, v3
    ds_read_b128 v[248:251], v3 offset:27648
    s_waitcnt lgkmcnt(0)
    v_mfma_f32_16x16x32_bf16 v[16:19], v[160:163], v[248:251], 0
    v_mfma_f32_16x16x32_bf16 v[20:23], v[164:167], v[248:251], 0
    v_mfma_f32_16x16x32_bf16 v[24:27], v[168:171], v[248:251], 0
    v_mfma_f32_16x16x32_bf16 v[28:31], v[172:175], v[248:251], 0
    s_barrier
    ds_read_b128 v[224:227], v7 offset:23040
    ds_read_b128 v[228:231], v7 offset:23104
    ds_read_b128 v[232:235], v7 offset:23168
    ds_read_b128 v[236:239], v7 offset:23232
    s_waitcnt lgkmcnt(3)
    v_mfma_f32_16x16x32_bf16 v[16:19], v[32:35], v[224:227], v[16:19]
    v_mfma_f32_16x16x32_bf16 v[20:23], v[48:51], v[224:227], v[20:23]
    v_mfma_f32_16x16x32_bf16 v[24:27], v[64:67], v[224:227], v[24:27]
    v_mfma_f32_16x16x32_bf16 v[28:31], v[80:83], v[224:227], v[28:31]
    s_waitcnt lgkmcnt(2)
    v_mfma_f32_16x16x32_bf16 v[16:19], v[36:39], v[228:231], v[16:19]
    v_mfma_f32_16x16x32_bf16 v[20:23], v[52:55], v[228:231], v[20:23]
    v_mfma_f32_16x16x32_bf16 v[24:27], v[68:71], v[228:231], v[24:27]
    v_mfma_f32_16x16x32_bf16 v[28:31], v[84:87], v[228:231], v[28:31]
    s_waitcnt lgkmcnt(1)
    v_mfma_f32_16x16x32_bf16 v[16:19], v[40:43], v[232:235], v[16:19]
    v_mfma_f32_16x16x32_bf16 v[20:23], v[56:59], v[232:235], v[20:23]
    v_mfma_f32_16x16x32_bf16 v[24:27], v[72:75], v[232:235], v[24:27]
    v_mfma_f32_16x16x32_bf16 v[28:31], v[88:91], v[232:235], v[28:31]
    s_waitcnt lgkmcnt(0)
    v_mfma_f32_16x16x32_bf16 v[16:19], v[44:47], v[236:239], v[16:19]
    v_mfma_f32_16x16x32_bf16 v[20:23], v[60:63], v[236:239], v[20:23]
    v_mfma_f32_16x16x32_bf16 v[24:27], v[76:79], v[236:239], v[24:27]
    v_mfma_f32_16x16x32_bf16 v[28:31], v[92:95], v[236:239], v[28:31]
    s_nop 5
    v_cndmask_b32 v240, v16, v20, s[80:81]
    v_cndmask_b32 v241, v17, v21, s[80:81]
    v_cndmask_b32 v242, v18, v22, s[80:81]
    v_cndmask_b32 v243, v19, v23, s[80:81]
    v_cndmask_b32 v240, v240, v24, s[76:77]
    v_cndmask_b32 v241, v241, v25, s[76:77]
    v_cndmask_b32 v242, v242, v26, s[76:77]
    v_cndmask_b32 v243, v243, v27, s[76:77]
    v_cndmask_b32 v240, v240, v28, s[78:79]
    v_cndmask_b32 v241, v241, v29, s[78:79]
    v_cndmask_b32 v242, v242, v30, s[78:79]
    v_cndmask_b32 v243, v243, v31, s[78:79]
    v_bfi_b32 v240, s68, v240, v12
    v_bfi_b32 v241, s68, v241, v13
    v_bfi_b32 v242, s68, v242, v14
    v_bfi_b32 v243, s68, v243, v15
    buffer_store_dwordx4 v[240:243], v6, s[52:55], s72 offen sc1
    s_cmp_ge_u32 s2, 64
    s_cbranch_scc1 L_exit_33
    v_lshrrev_b32 v10, 3, v0
    v_mul_u32_u24 v10, 8320, v10
    v_and_b32 v11, 7, v0
    v_lshl_add_u32 v10, v11, 4, v10
    s_mul_i32 s73, s56, 266240
    s_lshl_b32 s75, s2, 7
    s_add_u32 s73, s73, s75
    s_add_u32 s73, s73, 10485760
    s_add_u32 s74, s73, 66560
    s_add_u32 s78, s73, 133120
    s_add_u32 s79, s73, 199680
    v_and_b32 v7, 31, v0
    v_lshlrev_b32 v7, 1, v7
    s_lshl_b32 s72, s2, 6
    s_and_b32 s75, s72, 1023
    buffer_load_ushort v96, v7, s[4:7], s72 offen
    buffer_load_ushort v97, v7, s[40:43], s75 offen
    s_sleep 20
    buffer_load_dwordx4 v[32:35], v10, s[52:55], s73 offen sc1
    buffer_load_dwordx4 v[36:39], v10, s[52:55], s74 offen sc1
    buffer_load_dwordx4 v[40:43], v10, s[52:55], s78 offen sc1
    buffer_load_dwordx4 v[44:47], v10, s[52:55], s79 offen sc1
    s_mov_b32 s101, 15
    s_waitcnt vmcnt(0)
L_g_34:
    s_bitcmp1_b32 s101, 0
    s_cbranch_scc0 L_gs_36
    v_xor_b32 v32, s64, v32
    v_xor_b32 v33, s65, v33
    v_xor_b32 v34, s66, v34
    v_xor_b32 v35, s67, v35
    v_or3_b32 v3, v32, v33, v34
    v_or_b32 v3, v3, v35
    v_and_b32 v3, 0xfff, v3
    v_cmp_ne_u32 vcc, 0, v3
    s_bitset0_b32 s101, 0
    s_cbranch_vccz L_gs_36
    s_bitset1_b32 s101, 0
    buffer_load_dwordx4 v[32:35], v10, s[52:55], s73 offen sc1
L_gs_36:
    s_bitcmp1_b32 s101, 1
    s_cbranch_scc0 L_gs_37
    v_xor_b32 v36, s64, v36
    v_xor_b32 v37, s65, v37
    v_xor_b32 v38, s66, v38
    v_xor_b32 v39, s67, v39
    v_or3_b32 v3, v36, v37, v38
    v_or_b32 v3, v3, v39
    v_and_b32 v3, 0xfff, v3
    v_cmp_ne_u32 vcc, 0, v3
    s_bitset0_b32 s101, 1
    s_cbranch_vccz L_gs_37
    s_bitset1_b32 s101, 1
    buffer_load_dwordx4 v[36:39], v10, s[52:55], s74 offen sc1
L_gs_37:
    s_bitcmp1_b32 s101, 2
    s_cbranch_scc0 L_gs_38
    v_xor_b32 v40, s64, v40
    v_xor_b32 v41, s65, v41
    v_xor_b32 v42, s66, v42
    v_xor_b32 v43, s67, v43
    v_or3_b32 v3, v40, v41, v42
    v_or_b32 v3, v3, v43
    v_and_b32 v3, 0xfff, v3
    v_cmp_ne_u32 vcc, 0, v3
    s_bitset0_b32 s101, 2
    s_cbranch_vccz L_gs_38
    s_bitset1_b32 s101, 2
    buffer_load_dwordx4 v[40:43], v10, s[52:55], s78 offen sc1
L_gs_38:
    s_bitcmp1_b32 s101, 3
    s_cbranch_scc0 L_gs_39
    v_xor_b32 v44, s64, v44
    v_xor_b32 v45, s65, v45
    v_xor_b32 v46, s66, v46
    v_xor_b32 v47, s67, v47
    v_or3_b32 v3, v44, v45, v46
    v_or_b32 v3, v3, v47
    v_and_b32 v3, 0xfff, v3
    v_cmp_ne_u32 vcc, 0, v3
    s_bitset0_b32 s101, 3
    s_cbranch_vccz L_gs_39
    s_bitset1_b32 s101, 3
    buffer_load_dwordx4 v[44:47], v10, s[52:55], s79 offen sc1
L_gs_39:
    s_cmp_eq_u32 s101, 0
    s_cbranch_scc1 L_gdone_35
    s_add_u32 s82, s82, 0x10000
    s_cmp_gt_u32 s82, 0x40000000
    s_cbranch_scc1 L_gdone_35
    s_waitcnt vmcnt(0)
    s_branch L_g_34
L_gdone_35:
    v_pk_add_f32 v[32:33], v[32:33], v[36:37]
    v_pk_add_f32 v[34:35], v[34:35], v[38:39]
    v_pk_add_f32 v[40:41], v[40:41], v[44:45]
    v_pk_add_f32 v[42:43], v[42:43], v[46:47]
    v_pk_add_f32 v[32:33], v[32:33], v[40:41]
    v_pk_add_f32 v[34:35], v[34:35], v[42:43]
    v_lshlrev_b32 v11, 4, v11
    v_and_b32 v4, 1, v2
    v_permlane32_swap_b32 v32, v33
    v_permlane32_swap_b32 v34, v35
    v_add_f32 v32, v32, v33
    v_add_f32 v34, v34, v35
    v_lshl_add_u32 v11, v4, 3, v11
    v_lshrrev_b32 v4, 1, v2
    v_permlane16_swap_b32 v32, v34
    v_add_f32 v32, v32, v34
    v_lshl_add_u32 v11, v4, 2, v11
    s_lshl_b32 s74, s56, 7
    v_add_f32 v32, v32, v32 row_ror:8
    v_add_u32 v11, s74, v11
    ds_write_b32 v11, v32 offset:16640
    s_waitcnt lgkmcnt(0)
    s_barrier
    s_cmp_lg_u32 s56, 0
    s_cbranch_scc1 L_fin_40
    v_lshlrev_b32 v11, 1, v7
    ds_read_b32 v32, v11 offset:16640
    ds_read_b32 v33, v11 offset:16768
    ds_read_b32 v34, v11 offset:16896
    ds_read_b32 v35, v11 offset:17024
    ds_read_b32 v36, v11 offset:17152
    ds_read_b32 v37, v11 offset:17280
    ds_read_b32 v38, v11 offset:17408
    ds_read_b32 v39, v11 offset:17536
    v_lshlrev_b32 v96, 16, v96
    v_lshlrev_b32 v97, 16, v97
    v_add_f32 v96, v96, v97
    s_waitcnt lgkmcnt(0)
    v_add_f32 v32, v32, v36
    v_add_f32 v33, v33, v37
    v_add_f32 v34, v34, v38
    v_add_f32 v35, v35, v39
    v_add_f32 v32, v32, v34
    v_add_f32 v33, v33, v35
    v_add_f32 v32, v32, v33
    v_add_f32 v32, v32, v96
    v_cvt_pk_bf16_f32 v32, v32, v32
    s_mov_b64 exec, 0xffffffff
    buffer_store_short v32, v7, s[44:47], s72 offen
    s_mov_b64 exec, -1
L_fin_40:
L_exit_33:
    s_branch L_end
L_loader:
    v_lshlrev_b32 v3, 2, v0
    ds_write_b32 v3, v9 offset:27648
    s_mov_b64 exec, 0xffff
    ds_write_b32 v3, v9 offset:27920
    s_mov_b64 exec, -1
    s_mul_i32 s79, s83, 33792
    s_add_u32 s79, s79, 28672
    s_lshl_b32 s78, s62, 17
    s_lshl_b32 s72, s83, 15
    s_add_u32 s78, s78, s72
    s_waitcnt lgkmcnt(0)
    s_lshl_b32 s72, s83, 10
    buffer_load_dwordx4 v[160:163], v8, s[4:7], s72 offen
    v_add_u32 v3, s72, v8
    s_barrier
    s_waitcnt vmcnt(0)
    v_lshlrev_b32 v168, 16, v160
    v_and_b32 v169, 0xffff0000, v160
    v_lshlrev_b32 v170, 16, v161
    v_and_b32 v171, 0xffff0000, v161
    v_lshlrev_b32 v172, 16, v162
    v_and_b32 v173, 0xffff0000, v162
    v_lshlrev_b32 v174, 16, v163
    v_and_b32 v175, 0xffff0000, v163
    v_pk_add_f32 v[4:5], v[168:169], v[170:171]
    v_pk_add_f32 v[6:7], v[172:173], v[174:175]
    v_pk_add_f32 v[4:5], v[4:5], v[6:7]
    v_add_f32 v4, v4, v5
    s_nop 1
    v_add_f32 v4, v4, v4 row_ror:1
    s_nop 1
    v_add_f32 v4, v4, v4 row_ror:2
    s_nop 1
    v_add_f32 v4, v4, v4 row_ror:4
    s_nop 1
    v_add_f32 v4, v4, v4 row_ror:8
    v_mov_b32 v5, v4
    s_nop 1
    v_permlane16_swap_b32 v4, v5
    v_add_f32 v4, v4, v5
    v_mov_b32 v5, v4
    s_nop 1
    v_permlane32_swap_b32 v4, v5
    v_add_f32 v4, v4, v5
    v_mul_f32 v4, 0x3b000000, v4
    v_sub_f32 v176, v168, v4
    v_sub_f32 v177, v169, v4
    v_sub_f32 v178, v170, v4
    v_sub_f32 v179, v171, v4
    v_sub_f32 v180, v172, v4
    v_sub_f32 v181, v173, v4
    v_sub_f32 v182, v174, v4
    v_sub_f32 v183, v175, v4
    v_mul_f32 v6, v176, v176
    v_mul_f32 v7, v177, v177
    v_fmac_f32 v6, v178, v178
    v_fmac_f32 v7, v179, v179
    v_fmac_f32 v6, v180, v180
    v_fmac_f32 v7, v181, v181
    v_fmac_f32 v6, v182, v182
    v_fmac_f32 v7, v183, v183
    v_add_f32 v6, v6, v7
    s_nop 1
    v_add_f32 v6, v6, v6 row_ror:1
    s_nop 1
    v_add_f32 v6, v6, v6 row_ror:2
    s_nop 1
    v_add_f32 v6, v6, v6 row_ror:4
    s_nop 1
    v_add_f32 v6, v6, v6 row_ror:8
    v_mov_b32 v5, v6
    s_nop 1
    v_permlane16_swap_b32 v6, v5
    v_add_f32 v6, v6, v5
    v_mov_b32 v5, v6
    s_nop 1
    v_permlane32_swap_b32 v6, v5
    v_add_f32 v6, v6, v5
    v_mul_f32 v6, 0x3b000000, v6
    v_cvt_pk_bf16_f32 v4, v4, v6
    v_and_b32 v6, 0xffff0000, v4
    v_lshlrev_b32 v4, 16, v4
    v_add_f32 v6, 0x3727c5ac, v6
    v_cvt_pk_bf16_f32 v6, v6, v6
    v_lshlrev_b32 v6, 16, v6
    v_sqrt_f32 v6, v6
    v_sub_f32 v168, v168, v4
    v_sub_f32 v169, v169, v4
    v_sub_f32 v170, v170, v4
    v_sub_f32 v171, v171, v4
    v_sub_f32 v172, v172, v4
    v_sub_f32 v173, v173, v4
    v_sub_f32 v174, v174, v4
    v_sub_f32 v175, v175, v4
    v_cvt_pk_bf16_f32 v6, v6, v6
    v_lshlrev_b32 v6, 16, v6
    v_rcp_f32 v6, v6
    v_cvt_pk_bf16_f32 v160, v168, v169
    v_cvt_pk_bf16_f32 v161, v170, v171
    v_cvt_pk_bf16_f32 v162, v172, v173
    v_cvt_pk_bf16_f32 v163, v174, v175
    v_lshlrev_b32 v168, 16, v160
    v_and_b32 v169, 0xffff0000, v160
    v_lshlrev_b32 v170, 16, v161
    v_and_b32 v171, 0xffff0000, v161
    v_lshlrev_b32 v172, 16, v162
    v_and_b32 v173, 0xffff0000, v162
    v_lshlrev_b32 v174, 16, v163
    v_and_b32 v175, 0xffff0000, v163
    v_mul_f32 v168, v168, v6
    v_mul_f32 v169, v169, v6
    v_mul_f32 v170, v170, v6
    v_mul_f32 v171, v171, v6
    v_mul_f32 v172, v172, v6
    v_mul_f32 v173, v173, v6
    v_mul_f32 v174, v174, v6
    v_mul_f32 v175, v175, v6
    v_cvt_pk_bf16_f32 v160, v168, v169
    v_cvt_pk_bf16_f32 v161, v170, v171
    v_cvt_pk_bf16_f32 v162, v172, v173
    v_cvt_pk_bf16_f32 v163, v174, v175
    ds_write_b128 v3, v[160:163] offset:18432
    v_mov_b32 v3, 1
    s_mov_b64 exec, 1
    ds_add_u32 v9, v3 offset:27936
    s_mov_b64 exec, -1
    s_cmp_lg_u32 s56, 7
    s_cbranch_scc1 L_noncedone_41
    s_sleep 4
    s_load_dwordx2 s[76:77], s[48:49], 0
    s_waitcnt lgkmcnt(0)
    v_mov_b32 v10, s76
    v_mov_b32 v11, s77
    s_nop 0
L_noncepoll_42:
    v_readfirstlane_b32 s72, v11
    s_bitcmp1_b32 s72, 31
    s_cbranch_scc1 L_nonceok_43
    s_add_u32 s82, s82, 0x10000
    s_cmp_gt_u32 s82, 0x40000000
    s_cbranch_scc1 L_nonceok_43
    buffer_load_dwordx2 v[10:11], v9, s[48:51], 0 offen sc1
    s_waitcnt vmcnt(0)
    s_branch L_noncepoll_42
L_nonceok_43:
    ds_write_b64 v9, v[10:11] offset:27904
    v_mov_b32 v3, 1
    s_mov_b64 exec, 1
    ds_add_u32 v9, v3 offset:27952
    s_mov_b64 exec, -1
L_noncedone_41:
    v_lshrrev_b32 v6, 2, v1
    v_lshl_add_u32 v6, v2, 2, v6
    v_mul_u32_u24 v6, 1056, v6
    v_and_b32 v7, 3, v1
    v_lshl_add_u32 v6, v7, 3, v6
    s_lshl_b32 s72, s56, 7
    s_add_u32 s72, s72, 28672
    v_add_u32 v6, s72, v6
    v_add_u32 v7, 67584, v6
    s_lshl_b32 s72, s56, 4
    v_add_u32 v5, s72, v1
    v_mul_u32_u24 v5, 1056, v5
    v_lshl_add_u32 v5, v2, 4, v5
    v_add_u32 v5, 28672, v5
    s_mov_b32 m0, s79
    s_add_u32 s79, s79, 1056
    buffer_load_dwordx4 v8, s[8:11], s78 offen lds
    s_add_u32 s78, s78, 1024
    s_mov_b32 m0, s79
    s_add_u32 s79, s79, 1056
    buffer_load_dwordx4 v8, s[8:11], s78 offen lds
    s_add_u32 s78, s78, 1024
    s_mov_b32 m0, s79
    s_add_u32 s79, s79, 1056
    buffer_load_dwordx4 v8, s[8:11], s78 offen lds
    s_add_u32 s78, s78, 1024
    s_mov_b32 m0, s79
    s_add_u32 s79, s79, 1056
    buffer_load_dwordx4 v8, s[8:11], s78 offen lds
    s_add_u32 s78, s78, 1024
    s_mov_b32 m0, s79
    s_add_u32 s79, s79, 1056
    buffer_load_dwordx4 v8, s[8:11], s78 offen lds
    s_add_u32 s78, s78, 1024
    s_mov_b32 m0, s79
    s_add_u32 s79, s79, 1056
    buffer_load_dwordx4 v8, s[8:11], s78 offen lds
    s_add_u32 s78, s78, 1024
    s_waitcnt vmcnt(5)
    s_mov_b32 m0, s79
    s_add_u32 s79, s79, 1056
    buffer_load_dwordx4 v8, s[8:11], s78 offen lds
    s_add_u32 s78, s78, 1024
    s_waitcnt vmcnt(5)
    s_mov_b32 m0, s79
    s_add_u32 s79, s79, 1056
    buffer_load_dwordx4 v8, s[8:11], s78 offen lds
    s_add_u32 s78, s78, 1024
    s_waitcnt vmcnt(5)
    s_mov_b32 m0, s79
    s_add_u32 s79, s79, 1056
    buffer_load_dwordx4 v8, s[8:11], s78 offen lds
    s_add_u32 s78, s78, 1024
    s_waitcnt vmcnt(5)
    s_mov_b32 m0, s79
    s_add_u32 s79, s79, 1056
    buffer_load_dwordx4 v8, s[8:11], s78 offen lds
    s_add_u32 s78, s78, 1024
    s_waitcnt vmcnt(5)
    s_mov_b32 m0, s79
    s_add_u32 s79, s79, 1056
    buffer_load_dwordx4 v8, s[8:11], s78 offen lds
    s_add_u32 s78, s78, 1024
    s_waitcnt vmcnt(5)
    s_mov_b32 m0, s79
    s_add_u32 s79, s79, 1056
    buffer_load_dwordx4 v8, s[8:11], s78 offen lds
    s_add_u32 s78, s78, 1024
    s_waitcnt vmcnt(5)
    s_mov_b32 m0, s79
    s_add_u32 s79, s79, 1056
    buffer_load_dwordx4 v8, s[8:11], s78 offen lds
    s_add_u32 s78, s78, 1024
    s_waitcnt vmcnt(5)
    s_mov_b32 m0, s79
    s_add_u32 s79, s79, 1056
    buffer_load_dwordx4 v8, s[8:11], s78 offen lds
    s_add_u32 s78, s78, 1024
    s_waitcnt vmcnt(5)
    s_mov_b32 m0, s79
    s_add_u32 s79, s79, 1056
    buffer_load_dwordx4 v8, s[8:11], s78 offen lds
    s_add_u32 s78, s78, 1024
    s_waitcnt vmcnt(5)
    s_mov_b32 m0, s79
    s_add_u32 s79, s79, 1056
    buffer_load_dwordx4 v8, s[8:11], s78 offen lds
    s_add_u32 s78, s78, 1024
    s_waitcnt vmcnt(5)
    s_mov_b32 m0, s79
    s_add_u32 s79, s79, 1056
    buffer_load_dwordx4 v8, s[8:11], s78 offen lds
    s_add_u32 s78, s78, 1024
    s_waitcnt vmcnt(5)
    s_mov_b32 m0, s79
    s_add_u32 s79, s79, 1056
    buffer_load_dwordx4 v8, s[8:11], s78 offen lds
    s_add_u32 s78, s78, 1024
    s_waitcnt vmcnt(5)
    s_mov_b32 m0, s79
    s_add_u32 s79, s79, 1056
    buffer_load_dwordx4 v8, s[8:11], s78 offen lds
    s_add_u32 s78, s78, 1024
    s_waitcnt vmcnt(5)
    s_mov_b32 m0, s79
    s_add_u32 s79, s79, 1056
    buffer_load_dwordx4 v8, s[8:11], s78 offen lds
    s_add_u32 s78, s78, 1024
    s_waitcnt vmcnt(5)
    s_mov_b32 m0, s79
    s_add_u32 s79, s79, 1056
    buffer_load_dwordx4 v8, s[8:11], s78 offen lds
    s_add_u32 s78, s78, 1024
    s_waitcnt vmcnt(5)
    s_mov_b32 m0, s79
    s_add_u32 s79, s79, 1056
    buffer_load_dwordx4 v8, s[8:11], s78 offen lds
    s_add_u32 s78, s78, 1024
    s_waitcnt vmcnt(5)
    s_mov_b32 m0, s79
    s_add_u32 s79, s79, 1056
    buffer_load_dwordx4 v8, s[8:11], s78 offen lds
    s_add_u32 s78, s78, 1024
    s_waitcnt vmcnt(5)
    s_mov_b32 m0, s79
    s_add_u32 s79, s79, 1056
    buffer_load_dwordx4 v8, s[8:11], s78 offen lds
    s_add_u32 s78, s78, 1024
    s_waitcnt vmcnt(5)
    s_mov_b32 m0, s79
    s_add_u32 s79, s79, 1056
    buffer_load_dwordx4 v8, s[8:11], s78 offen lds
    s_add_u32 s78, s78, 1024
    s_waitcnt vmcnt(5)
    s_mov_b32 m0, s79
    s_add_u32 s79, s79, 1056
    buffer_load_dwordx4 v8, s[8:11], s78 offen lds
    s_add_u32 s78, s78, 1024
    s_waitcnt vmcnt(5)
    s_mov_b32 m0, s79
    s_add_u32 s79, s79, 1056
    buffer_load_dwordx4 v8, s[8:11], s78 offen lds
    s_add_u32 s78, s78, 1024
    s_waitcnt vmcnt(5)
    s_mov_b32 m0, s79
    s_add_u32 s79, s79, 1056
    buffer_load_dwordx4 v8, s[8:11], s78 offen lds
    s_add_u32 s78, s78, 1024
    s_waitcnt vmcnt(5)
    s_mov_b32 m0, s79
    s_add_u32 s79, s79, 1056
    buffer_load_dwordx4 v8, s[8:11], s78 offen lds
    s_add_u32 s78, s78, 1024
    s_waitcnt vmcnt(5)
    s_mov_b32 m0, s79
    s_add_u32 s79, s79, 1056
    buffer_load_dwordx4 v8, s[8:11], s78 offen lds
    s_add_u32 s78, s78, 1024
    s_waitcnt vmcnt(5)
    s_mov_b32 m0, s79
    s_add_u32 s79, s79, 1056
    buffer_load_dwordx4 v8, s[8:11], s78 offen lds
    s_add_u32 s78, s78, 1024
    s_waitcnt vmcnt(5)
    s_mov_b32 m0, s79
    s_add_u32 s79, s79, 1056
    buffer_load_dwordx4 v8, s[8:11], s78 offen lds
    s_add_u32 s78, s78, 1024
    s_add_u32 s72, s58, s83
    s_and_b32 s72, s72, 7
    s_lshl_b32 s72, s72, 4
    s_mul_i32 s80, s72, 1056
    s_lshl_b32 s73, s57, 7
    s_add_u32 s72, s72, s73
    s_lshl_b32 s72, s72, 10
    s_mov_b32 s78, s72
    s_waitcnt vmcnt(5)
    buffer_load_dwordx4 v[96:99], v8, s[24:27], s78 offen offset:0
    s_waitcnt vmcnt(5)
    buffer_load_dwordx4 v[100:103], v8, s[24:27], s78 offen offset:1024
    s_waitcnt vmcnt(5)
    buffer_load_dwordx4 v[104:107], v8, s[24:27], s78 offen offset:2048
    s_waitcnt vmcnt(5)
    buffer_load_dwordx4 v[108:111], v8, s[24:27], s78 offen offset:3072
    s_add_u32 s78, s78, 4096
    s_waitcnt vmcnt(5)
    buffer_load_dwordx4 v[112:115], v8, s[24:27], s78 offen offset:0
    s_waitcnt vmcnt(5)
    buffer_load_dwordx4 v[116:119], v8, s[24:27], s78 offen offset:1024
    s_waitcnt vmcnt(5)
    buffer_load_dwordx4 v[120:123], v8, s[24:27], s78 offen offset:2048
    s_waitcnt vmcnt(5)
    buffer_load_dwordx4 v[124:127], v8, s[24:27], s78 offen offset:3072
    s_add_u32 s78, s78, 4096
    s_waitcnt vmcnt(8)
    v_mov_b32 v3, 1
    s_mov_b64 exec, 1
    ds_add_u32 v9, v3 offset:27948
    s_mov_b64 exec, -1
    s_waitcnt vmcnt(5)
    buffer_load_dwordx4 v[128:131], v8, s[24:27], s78 offen offset:0
    s_waitcnt vmcnt(5)
    buffer_load_dwordx4 v[132:135], v8, s[24:27], s78 offen offset:1024
    s_waitcnt vmcnt(5)
    buffer_load_dwordx4 v[136:139], v8, s[24:27], s78 offen offset:2048
    s_waitcnt vmcnt(5)
    buffer_load_dwordx4 v[140:143], v8, s[24:27], s78 offen offset:3072
    s_add_u32 s78, s78, 4096
    s_waitcnt vmcnt(5)
    buffer_load_dwordx4 v[144:147], v8, s[24:27], s78 offen offset:0
    s_waitcnt vmcnt(5)
    buffer_load_dwordx4 v[148:151], v8, s[24:27], s78 offen offset:1024
    s_waitcnt vmcnt(5)
    buffer_load_dwordx4 v[152:155], v8, s[24:27], s78 offen offset:2048
    s_waitcnt vmcnt(5)
    buffer_load_dwordx4 v[156:159], v8, s[24:27], s78 offen offset:3072
    v_lshlrev_b32 v3, 16, v2
    v_lshl_add_u32 v3, v1, 2, v3
    s_lshl_b32 s72, s58, 19
    s_lshl_b32 s73, s57, 8
    s_add_u32 s72, s72, s73
    s_lshl_b32 s73, s83, 6
    s_add_u32 s72, s72, s73
    buffer_load_dword v16, v3, s[20:23], s72 offen
    s_add_u32 s72, s72, 8192
    buffer_load_dword v17, v3, s[20:23], s72 offen
    s_add_u32 s72, s72, 8192
    buffer_load_dword v18, v3, s[20:23], s72 offen
    s_add_u32 s72, s72, 8192
    buffer_load_dword v19, v3, s[20:23], s72 offen
    s_add_u32 s72, s72, 8192
    buffer_load_dword v20, v3, s[20:23], s72 offen
    s_add_u32 s72, s72, 8192
    buffer_load_dword v21, v3, s[20:23], s72 offen
    s_add_u32 s72, s72, 8192
    buffer_load_dword v22, v3, s[20:23], s72 offen
    s_add_u32 s72, s72, 8192
    buffer_load_dword v23, v3, s[20:23], s72 offen
    s_add_u32 s72, s72, 204800
    buffer_load_dword v24, v3, s[20:23], s72 offen
    s_add_u32 s72, s72, 8192
    buffer_load_dword v25, v3, s[20:23], s72 offen
    s_add_u32 s72, s72, 8192
    buffer_load_dword v26, v3, s[20:23], s72 offen
    s_add_u32 s72, s72, 8192
    buffer_load_dword v27, v3, s[20:23], s72 offen
    s_add_u32 s72, s72, 8192
    buffer_load_dword v28, v3, s[20:23], s72 offen
    s_add_u32 s72, s72, 8192
    buffer_load_dword v29, v3, s[20:23], s72 offen
    s_add_u32 s72, s72, 8192
    buffer_load_dword v30, v3, s[20:23], s72 offen
    s_add_u32 s72, s72, 8192
    buffer_load_dword v31, v3, s[20:23], s72 offen
L_cw_44:
    ds_read_b32 v3, v9 offset:27948
    s_add_u32 s82, s82, 1
    s_cmp_gt_u32 s82, 0x60000000
    s_cbranch_scc1 L_cwok_45
    s_waitcnt lgkmcnt(0)
    v_readfirstlane_b32 s100, v3
    s_cmp_ge_u32 s100, 4
    s_cbranch_scc0 L_cw_44
L_cwok_45:
    s_waitcnt lgkmcnt(0)
    ds_read_b128 v[32:35], v5 offset:0
    ds_read_b128 v[36:39], v5 offset:64
    ds_read_b128 v[40:43], v5 offset:128
    ds_read_b128 v[44:47], v5 offset:192
    ds_read_b128 v[48:51], v5 offset:256
    ds_read_b128 v[52:55], v5 offset:320
    ds_read_b128 v[56:59], v5 offset:384
    ds_read_b128 v[60:63], v5 offset:448
    ds_read_b128 v[64:67], v5 offset:512
    ds_read_b128 v[68:71], v5 offset:576
    ds_read_b128 v[72:75], v5 offset:640
    ds_read_b128 v[76:79], v5 offset:704
    ds_read_b128 v[80:83], v5 offset:768
    ds_read_b128 v[84:87], v5 offset:832
    ds_read_b128 v[88:91], v5 offset:896
    ds_read_b128 v[92:95], v5 offset:960
    ds_read_b64_tr_b16 v[160:161], v6 offset:0
    ds_read_b64_tr_b16 v[162:163], v6 offset:16896
    ds_read_b64_tr_b16 v[176:177], v6 offset:32
    ds_read_b64_tr_b16 v[178:179], v6 offset:16928
    ds_read_b64_tr_b16 v[192:193], v6 offset:64
    ds_read_b64_tr_b16 v[194:195], v6 offset:16960
    ds_read_b64_tr_b16 v[208:209], v6 offset:96
    ds_read_b64_tr_b16 v[210:211], v6 offset:16992
    ds_read_b64_tr_b16 v[164:165], v6 offset:33792
    ds_read_b64_tr_b16 v[166:167], v6 offset:50688
    ds_read_b64_tr_b16 v[180:181], v6 offset:33824
    ds_read_b64_tr_b16 v[182:183], v6 offset:50720
    ds_read_b64_tr_b16 v[196:197], v6 offset:33856
    ds_read_b64_tr_b16 v[198:199], v6 offset:50752
    ds_read_b64_tr_b16 v[212:213], v6 offset:33888
    ds_read_b64_tr_b16 v[214:215], v6 offset:50784
    ds_read_b64_tr_b16 v[168:169], v7 offset:0
    ds_read_b64_tr_b16 v[170:171], v7 offset:16896
    ds_read_b64_tr_b16 v[184:185], v7 offset:32
    ds_read_b64_tr_b16 v[186:187], v7 offset:16928
    ds_read_b64_tr_b16 v[200:201], v7 offset:64
    ds_read_b64_tr_b16 v[202:203], v7 offset:16960
    ds_read_b64_tr_b16 v[216:217], v7 offset:96
    ds_read_b64_tr_b16 v[218:219], v7 offset:16992
    ds_read_b64_tr_b16 v[172:173], v7 offset:33792
    ds_read_b64_tr_b16 v[174:175], v7 offset:50688
    ds_read_b64_tr_b16 v[188:189], v7 offset:33824
    ds_read_b64_tr_b16 v[190:191], v7 offset:50720
    ds_read_b64_tr_b16 v[204:205], v7 offset:33856
    ds_read_b64_tr_b16 v[206:207], v7 offset:50752
    ds_read_b64_tr_b16 v[220:221], v7 offset:33888
    ds_read_b64_tr_b16 v[222:223], v7 offset:50784
    s_waitcnt lgkmcnt(0)
    ds_read_b64 v[10:11], v9 offset:27904
    s_waitcnt lgkmcnt(0)
    v_readfirstlane_b32 s76, v10
    v_readfirstlane_b32 s77, v11
    s_nop 0
    s_and_b32 s64, s76, 0xfff
    s_bfe_u32 s65, s76, 0xc000c
    s_lshr_b64 s[76:77], s[76:77], 24
    s_and_b32 s66, s76, 0xfff
    s_bfe_u32 s67, s76, 0xc000c
    v_mov_b32 v12, s64
    v_mov_b32 v13, s65
    v_mov_b32 v14, s66
    v_mov_b32 v15, s67
    v_readfirstlane_b32 s87, v10
    s_lshr_b32 s76, s76, 8
    s_lshl_b32 s84, s76, 30
    s_lshr_b32 s76, s76, 2
    s_lshl_b32 s85, s76, 30
    s_lshr_b32 s76, s76, 2
    s_lshl_b32 s86, s76, 28
    v_mov_b32 v250, s84
    v_mov_b32 v251, s85
    v_mov_b32 v252, s86
    v_mov_b32 v253, s87
L_cw_46:
    ds_read_b32 v3, v9 offset:27928
    s_add_u32 s82, s82, 1
    s_cmp_gt_u32 s82, 0x60000000
    s_cbranch_scc1 L_cwok_47
    s_waitcnt lgkmcnt(0)
    v_readfirstlane_b32 s100, v3
    s_cmp_ge_u32 s100, 4
    s_cbranch_scc0 L_cw_46
L_cwok_47:
    s_waitcnt lgkmcnt(0)
    v_mul_u32_u24 v10, 1056, v1
    v_lshl_add_u32 v10, v2, 4, v10
    ds_read_b128 v[228:231], v10 offset:0
    ds_read_b128 v[232:235], v10 offset:64
    ds_read_b128 v[236:239], v10 offset:128
    ds_read_b128 v[240:243], v10 offset:192
    ds_read_b128 v[244:247], v10 offset:256
    v_lshlrev_b32 v4, 5, v1
    s_lshl_b32 s72, s56, 2
    v_add_u32 v11, s72, v4
    s_waitcnt lgkmcnt(4)
    v_mfma_f32_16x16x32_bf16 v[224:227], v[32:35], v[228:231], 0
    ds_read_b128 v[228:231], v10 offset:320
    s_waitcnt lgkmcnt(4)
    v_mfma_f32_16x16x32_bf16 v[224:227], v[36:39], v[232:235], v[224:227]
    ds_read_b128 v[232:235], v10 offset:384
    s_waitcnt lgkmcnt(4)
    v_mfma_f32_16x16x32_bf16 v[224:227], v[40:43], v[236:239], v[224:227]
    ds_read_b128 v[236:239], v10 offset:448
    s_waitcnt lgkmcnt(4)
    v_mfma_f32_16x16x32_bf16 v[224:227], v[44:47], v[240:243], v[224:227]
    ds_read_b128 v[240:243], v10 offset:512
    s_waitcnt lgkmcnt(4)
    v_mfma_f32_16x16x32_bf16 v[224:227], v[48:51], v[244:247], v[224:227]
    ds_read_b128 v[244:247], v10 offset:576
    s_waitcnt lgkmcnt(4)
    v_mfma_f32_16x16x32_bf16 v[224:227], v[52:55], v[228:231], v[224:227]
    ds_read_b128 v[228:231], v10 offset:640
    s_waitcnt lgkmcnt(4)
    v_mfma_f32_16x16x32_bf16 v[224:227], v[56:59], v[232:235], v[224:227]
    ds_read_b128 v[232:235], v10 offset:704
    s_waitcnt lgkmcnt(4)
    v_mfma_f32_16x16x32_bf16 v[224:227], v[60:63], v[236:239], v[224:227]
    ds_read_b128 v[236:239], v10 offset:768
    s_waitcnt lgkmcnt(4)
    v_mfma_f32_16x16x32_bf16 v[224:227], v[64:67], v[240:243], v[224:227]
    ds_read_b128 v[240:243], v10 offset:832
    s_waitcnt lgkmcnt(4)
    v_mfma_f32_16x16x32_bf16 v[224:227], v[68:71], v[244:247], v[224:227]
    ds_read_b128 v[244:247], v10 offset:896
    s_waitcnt lgkmcnt(4)
    v_mfma_f32_16x16x32_bf16 v[224:227], v[72:75], v[228:231], v[224:227]
    ds_read_b128 v[228:231], v10 offset:960
    s_waitcnt lgkmcnt(4)
    v_mfma_f32_16x16x32_bf16 v[224:227], v[76:79], v[232:235], v[224:227]
    s_waitcnt lgkmcnt(3)
    v_mfma_f32_16x16x32_bf16 v[224:227], v[80:83], v[236:239], v[224:227]
    s_waitcnt lgkmcnt(2)
    v_mfma_f32_16x16x32_bf16 v[224:227], v[84:87], v[240:243], v[224:227]
    s_waitcnt lgkmcnt(1)
    v_mfma_f32_16x16x32_bf16 v[224:227], v[88:91], v[244:247], v[224:227]
    s_waitcnt lgkmcnt(0)
    v_mfma_f32_16x16x32_bf16 v[224:227], v[92:95], v[228:231], v[224:227]
    s_lshr_b32 s72, s56, 1
    s_lshl_b32 s72, s72, 10
    s_and_b32 s73, s56, 1
    s_lshl_b32 s73, s73, 3
    s_add_u32 s72, s72, s73
    v_add_u32 v10, s72, v8
    s_nop 1
    v_max3_f32 v5, v224, v225, v226
    v_max_f32 v5, v5, v227
    v_mov_b32 v3, v5
    s_nop 1
    v_permlane16_swap_b32 v5, v3
    v_max_f32 v5, v5, v3
    v_mov_b32 v3, v5
    s_nop 1
    v_permlane32_swap_b32 v5, v3
    v_max_f32 v5, v5, v3
    ds_write_b32 v11, v5 offset:26624
    s_waitcnt lgkmcnt(0)
    s_barrier
    ds_read_b128 v[232:235], v4 offset:26624
    ds_read_b128 v[236:239], v4 offset:26640
    v_mul_u32_u24 v3, 3584, v0
    s_mul_i32 s72, s56, 229376
    s_lshl_b32 s73, s63, 1
    s_add_u32 s72, s72, s73
    s_lshl_b32 s73, s56, 10
    s_add_u32 s73, s73, 8448
    s_mov_b32 m0, s73
    s_add_u32 s73, s63, s56
    buffer_load_dwordx4 v3, s[28:31], s72 offen lds
    s_lshl_b32 s73, s73, 10
    s_mul_i32 s72, s56, 1056
    s_mov_b32 m0, s72
    s_nop 0
    buffer_load_dwordx4 v8, s[36:39], s73 offen lds
    s_waitcnt lgkmcnt(0)
    v_max3_f32 v5, v232, v233, v234
    v_max3_f32 v3, v235, v236, v237
    v_max3_f32 v5, v5, v238, v239
    v_max_f32 v5, v5, v3
    v_mul_f32 v5, s71, v5
    v_fma_f32 v224, v224, s71, -v5
    v_fma_f32 v225, v225, s71, -v5
    v_fma_f32 v226, v226, s71, -v5
    v_fma_f32 v227, v227, s71, -v5
    v_exp_f32 v224, v224
    v_exp_f32 v225, v225
    v_exp_f32 v226, v226
    v_exp_f32 v227, v227
    s_nop 0
    v_pk_add_f32 v[232:233], v[224:225], v[226:227]
    v_cvt_pk_bf16_f32 v224, v224, v225
    v_cvt_pk_bf16_f32 v225, v226, v227
    ds_write_b64 v10, v[224:225] offset:22528
    v_add_f32 v232, v232, v233
    v_mov_b32 v233, v232
    s_nop 1
    v_permlane16_swap_b32 v232, v233
    v_add_f32 v232, v232, v233
    v_mov_b32 v233, v232
    s_nop 1
    v_permlane32_swap_b32 v232, v233
    v_add_f32 v232, v232, v233
    ds_write_b32 v11, v232 offset:27136
    v_and_b32 v4, 7, v1
    v_mul_u32_u24 v4, 131072, v4
    v_lshl_add_u32 v4, v2, 4, v4
    v_lshrrev_b32 v3, 3, v1
    v_lshl_add_u32 v4, v3, 6, v4
    s_mov_b32 vcc_lo, 0xff00ff00
    s_mov_b32 vcc_hi, 0xff00ff00
    s_mul_i32 s72, s61, 2097152
    s_mul_i32 s73, s56, 16384
    s_add_u32 s72, s72, s73
    s_lshl_b32 s73, s59, 12
    s_add_u32 s72, s72, s73
    s_lshl_b32 s73, s60, 7
    s_add_u32 s72, s72, s73
    s_add_u32 s72, s72, 1048576
    s_add_u32 s74, s72, 1048576
    s_waitcnt lgkmcnt(0)
    s_barrier
    ds_read_b128 v[224:227], v8 offset:22528
    ds_read_b128 v[228:231], v8 offset:23552
    ds_read_b128 v[232:235], v8 offset:24576
    ds_read_b128 v[236:239], v8 offset:25600
    s_waitcnt lgkmcnt(3)
    v_mfma_f32_16x16x32_bf16 v[32:35], v[160:163], v[224:227], 0
    v_mfma_f32_16x16x32_bf16 v[36:39], v[176:179], v[224:227], 0
    s_waitcnt lgkmcnt(2)
    v_mfma_f32_16x16x32_bf16 v[32:35], v[164:167], v[228:231], v[32:35]
    v_mfma_f32_16x16x32_bf16 v[36:39], v[180:183], v[228:231], v[36:39]
    s_waitcnt lgkmcnt(1)
    v_mfma_f32_16x16x32_bf16 v[32:35], v[168:171], v[232:235], v[32:35]
    v_mfma_f32_16x16x32_bf16 v[36:39], v[184:187], v[232:235], v[36:39]
    s_waitcnt lgkmcnt(0)
    v_mfma_f32_16x16x32_bf16 v[32:35], v[172:175], v[236:239], v[32:35]
    v_mfma_f32_16x16x32_bf16 v[36:39], v[188:191], v[236:239], v[36:39]
    v_mfma_f32_16x16x32_bf16 v[40:43], v[192:195], v[224:227], 0
    v_mfma_f32_16x16x32_bf16 v[44:47], v[208:211], v[224:227], 0
    v_mfma_f32_16x16x32_bf16 v[40:43], v[196:199], v[228:231], v[40:43]
    v_mfma_f32_16x16x32_bf16 v[44:47], v[212:215], v[228:231], v[44:47]
    v_mfma_f32_16x16x32_bf16 v[40:43], v[200:203], v[232:235], v[40:43]
    v_mfma_f32_16x16x32_bf16 v[44:47], v[216:219], v[232:235], v[44:47]
    v_mfma_f32_16x16x32_bf16 v[40:43], v[204:207], v[236:239], v[40:43]
    v_mfma_f32_16x16x32_bf16 v[44:47], v[220:223], v[236:239], v[44:47]
    v_max3_f32 v6, |v32|, |v33|, |v34|
    v_max3_f32 v7, |v35|, |v36|, |v37|
    v_max3_f32 v6, |v38|, |v39|, v6
    v_max_f32 v6, v6, v7
    v_and_b32 v6, 0x7f800000, v6
    v_max_u32 v6, 0x08000000, v6
    v_sub_u32 v7, 0x82ff8000, v6
    v_fma_f32 v32, v32, v7, s91
    v_fma_f32 v33, v33, v7, s91
    v_fma_f32 v34, v34, v7, s91
    v_fma_f32 v35, v35, v7, s91
    v_fma_f32 v36, v36, v7, s91
    v_fma_f32 v37, v37, v7, s91
    v_fma_f32 v38, v38, v7, s91
    v_fma_f32 v39, v39, v7, s91
    v_lshrrev_b32 v6, 3, v6
    v_lshlrev_b32 v33, 10, v33
    v_lshlrev_b32 v36, 10, v36
    v_lshlrev_b32 v39, 10, v39
    v_lshlrev_b32 v34, 20, v34
    v_lshlrev_b32 v37, 20, v37
    v_or_b32 v6, v6, v252
    v_bfi_b32 v32, s88, v32, v250
    v_bfi_b32 v35, s88, v35, v251
    v_bfi_b32 v38, s88, v38, v6
    v_bfi_b32 v32, s89, v33, v32
    v_bfi_b32 v35, s89, v36, v35
    v_bfi_b32 v50, s89, v39, v38
    v_bfi_b32 v48, s90, v34, v32
    v_bfi_b32 v49, s90, v37, v35
    v_mov_b32 v51, v253
    v_max3_f32 v6, |v40|, |v41|, |v42|
    v_max3_f32 v7, |v43|, |v44|, |v45|
    v_max3_f32 v6, |v46|, |v47|, v6
    v_max_f32 v6, v6, v7
    v_and_b32 v6, 0x7f800000, v6
    v_max_u32 v6, 0x08000000, v6
    v_sub_u32 v7, 0x82ff8000, v6
    v_fma_f32 v40, v40, v7, s91
    v_fma_f32 v41, v41, v7, s91
    v_fma_f32 v42, v42, v7, s91
    v_fma_f32 v43, v43, v7, s91
    v_fma_f32 v44, v44, v7, s91
    v_fma_f32 v45, v45, v7, s91
    v_fma_f32 v46, v46, v7, s91
    v_fma_f32 v47, v47, v7, s91
    v_lshrrev_b32 v6, 3, v6
    v_lshlrev_b32 v41, 10, v41
    v_lshlrev_b32 v44, 10, v44
    v_lshlrev_b32 v47, 10, v47
    v_lshlrev_b32 v42, 20, v42
    v_lshlrev_b32 v45, 20, v45
    v_or_b32 v6, v6, v252
    v_bfi_b32 v40, s88, v40, v250
    v_bfi_b32 v43, s88, v43, v251
    v_bfi_b32 v46, s88, v46, v6
    v_bfi_b32 v40, s89, v41, v40
    v_bfi_b32 v43, s89, v44, v43
    v_bfi_b32 v54, s89, v47, v46
    v_bfi_b32 v52, s90, v42, v40
    v_bfi_b32 v53, s90, v45, v43
    v_mov_b32 v55, v253
    v_cndmask_b32 v56, v52, v48, vcc
    v_cndmask_b32 v57, v53, v49, vcc
    v_cndmask_b32 v58, v54, v50, vcc
    s_nop 0
    v_mov_b32 v60, v56 row_ror:8
    v_mov_b32 v61, v57 row_ror:8
    v_mov_b32 v62, v58 row_ror:8
    v_cndmask_b32 v48, v48, v60, vcc
    v_cndmask_b32 v49, v49, v61, vcc
    v_cndmask_b32 v50, v50, v62, vcc
    buffer_store_dwordx4 v[48:51], v4, s[52:55], s72 offen sc1
    v_cndmask_b32 v52, v60, v52, vcc
    v_cndmask_b32 v53, v61, v53, vcc
    v_cndmask_b32 v54, v62, v54, vcc
    buffer_store_dwordx4 v[52:55], v4, s[52:55], s74 offen sc1
    s_cmp_lg_u32 s56, 7
    s_cbranch_scc1 L_statdone_48
    v_lshlrev_b32 v3, 5, v1
    ds_read_b128 v[208:211], v3 offset:27136
    ds_read_b128 v[212:215], v3 offset:27152
    s_waitcnt lgkmcnt(0)
    v_pk_add_f32 v[208:209], v[208:209], v[210:211]
    v_pk_add_f32 v[212:213], v[212:213], v[214:215]
    v_pk_add_f32 v[208:209], v[208:209], v[212:213]
    v_add_f32 v208, v208, v209
    v_lshlrev_b32 v3, 11, v1
    s_lshl_b32 s72, s61, 15
    s_lshl_b32 s73, s59, 9
    s_add_u32 s72, s72, s73
    s_lshl_b32 s73, s60, 4
    s_add_u32 s72, s72, s73
    s_add_u32 s72, s72, 9437184
    v_bfi_b32 v216, s68, v5, v12
    v_bfi_b32 v217, s68, v208, v13
    v_lshl_or_b32 v218, v5, 20, v14
    v_lshl_or_b32 v219, v208, 20, v15
    s_mov_b64 exec, 0xffff
    buffer_store_dwordx4 v[216:219], v3, s[52:55], s72 offen sc1
    s_mov_b64 exec, -1
    s_nop 1
L_statdone_48:
    v_lshrrev_b32 v4, 2, v0
    v_and_b32 v4, 7, v4
    v_lshlrev_b32 v4, 1, v4
    s_lshl_b32 s74, s63, 1
    buffer_load_ushort v11, v4, s[32:35], s74 offen
    s_add_u32 s80, s80, 28672
    v_add_u32 v3, s80, v8
    s_waitcnt vmcnt(21)
    ds_write_b128 v3, v[96:99] offset:0
    ds_write_b128 v3, v[100:103] offset:1056
    ds_write_b128 v3, v[104:107] offset:2112
    ds_write_b128 v3, v[108:111] offset:3168
    ds_write_b128 v3, v[112:115] offset:4224
    ds_write_b128 v3, v[116:119] offset:5280
    ds_write_b128 v3, v[120:123] offset:6336
    ds_write_b128 v3, v[124:127] offset:7392
    ds_write_b128 v3, v[128:131] offset:8448
    ds_write_b128 v3, v[132:135] offset:9504
    ds_write_b128 v3, v[136:139] offset:10560
    ds_write_b128 v3, v[140:143] offset:11616
    ds_write_b128 v3, v[144:147] offset:12672
    ds_write_b128 v3, v[148:151] offset:13728
    ds_write_b128 v3, v[152:155] offset:14784
    ds_write_b128 v3, v[156:159] offset:15840
    v_lshrrev_b32 v5, 2, v1
    v_lshl_add_u32 v6, v2, 3, v5
    v_mul_u32_u24 v6, 1056, v6
    v_mul_u32_u24 v5, 1056, v5
    v_and_b32 v7, 3, v1
    v_lshlrev_b32 v7, 3, v7
    s_lshl_b32 s72, s56, 7
    v_add_u32 v7, s72, v7
    v_add_u32 v5, v5, v7
    v_add_u32 v6, v6, v7
    v_add_u32 v6, 28672, v6
    v_add_u32 v7, 67584, v6
    v_and_b32 v4, 3, v1
    v_lshlrev_b32 v4, 10, v4
    v_lshl_add_u32 v4, v2, 4, v4
    s_lshl_b32 s72, s83, 8
    v_add_u32 v4, s72, v4
    ds_read_b128 v[208:211], v4 offset:18432
    ds_read_b128 v[212:215], v4 offset:18496
    ds_read_b128 v[216:219], v4 offset:18560
    ds_read_b128 v[220:223], v4 offset:18624
    v_lshrrev_b32 v10, 2, v1
    v_lshl_add_u32 v10, v2, 3, v10
    v_lshlrev_b32 v10, 4, v10
    v_and_b32 v4, 1, v1
    v_lshl_add_u32 v10, v4, 3, v10
    s_lshl_b32 s72, s83, 11
    v_add_u32 v10, s72, v10
    s_waitcnt vmcnt(0)
    v_perm_b32 v176, v17, v16, s69
    v_perm_b32 v177, v19, v18, s69
    v_perm_b32 v178, v21, v20, s69
    v_perm_b32 v179, v23, v22, s69
    v_perm_b32 v180, v17, v16, s70
    v_perm_b32 v181, v19, v18, s70
    v_perm_b32 v182, v21, v20, s70
    v_perm_b32 v183, v23, v22, s70
    v_perm_b32 v184, v25, v24, s69
    v_perm_b32 v185, v27, v26, s69
    v_perm_b32 v186, v29, v28, s69
    v_perm_b32 v187, v31, v30, s69
    v_perm_b32 v188, v25, v24, s70
    v_perm_b32 v189, v27, v26, s70
    v_perm_b32 v190, v29, v28, s70
    v_perm_b32 v191, v31, v30, s70
    s_waitcnt vmcnt(3)
    v_mov_b32 v3, 1
    s_mov_b64 exec, 1
    ds_add_u32 v9, v3 offset:27956
    s_mov_b64 exec, -1
L_cw_49:
    ds_read_b32 v3, v9 offset:27956
    s_add_u32 s82, s82, 1
    s_cmp_gt_u32 s82, 0x60000000
    s_cbranch_scc1 L_cwok_50
    s_waitcnt lgkmcnt(0)
    v_readfirstlane_b32 s100, v3
    s_cmp_ge_u32 s100, 8
    s_cbranch_scc0 L_cw_49
L_cwok_50:
    s_waitcnt lgkmcnt(0)
    ds_read_b64_tr_b16 v[224:225], v10 offset:8448
    ds_read_b64_tr_b16 v[226:227], v10 offset:8512
    ds_read_b64_tr_b16 v[228:229], v10 offset:8960
    ds_read_b64_tr_b16 v[230:231], v10 offset:9024
    ds_read_b64_tr_b16 v[232:233], v10 offset:9472
    ds_read_b64_tr_b16 v[234:235], v10 offset:9536
    ds_read_b64_tr_b16 v[236:237], v10 offset:9984
    ds_read_b64_tr_b16 v[238:239], v10 offset:10048
    s_lshl_b32 s72, s83, 8
    v_lshlrev_b32 v4, 4, v1
    v_add_u32 v4, s72, v4
    s_waitcnt lgkmcnt(0)
    v_mfma_f32_16x16x32_bf16 v[240:243], v[208:211], v[224:227], 0
    v_mfma_f32_16x16x32_bf16 v[240:243], v[212:215], v[228:231], v[240:243]
    v_mfma_f32_16x16x32_bf16 v[240:243], v[216:219], v[232:235], v[240:243]
    v_mfma_f32_16x16x32_bf16 v[240:243], v[220:223], v[236:239], v[240:243]
    s_mov_b64 exec, 0xffff
    s_nop 7
    ds_write_b128 v4, v[240:243] offset:16640
    s_mov_b64 exec, -1
    v_mov_b32 v3, 1
    s_mov_b64 exec, 1
    ds_add_u32 v9, v3 offset:27932
    s_mov_b64 exec, -1
    ds_read_b64_tr_b16 v[160:161], v5 offset:0
    ds_read_b64_tr_b16 v[162:163], v5 offset:4224
    ds_read_b64_tr_b16 v[164:165], v5 offset:32
    ds_read_b64_tr_b16 v[166:167], v5 offset:4256
    ds_read_b64_tr_b16 v[168:169], v5 offset:64
    ds_read_b64_tr_b16 v[170:171], v5 offset:4288
    ds_read_b64_tr_b16 v[172:173], v5 offset:96
    ds_read_b64_tr_b16 v[174:175], v5 offset:4320
    ds_read_b64_tr_b16 v[32:33], v6 offset:0
    ds_read_b64_tr_b16 v[34:35], v6 offset:4224
    ds_read_b64_tr_b16 v[48:49], v6 offset:32
    ds_read_b64_tr_b16 v[50:51], v6 offset:4256
    ds_read_b64_tr_b16 v[64:65], v6 offset:64
    ds_read_b64_tr_b16 v[66:67], v6 offset:4288
    ds_read_b64_tr_b16 v[80:81], v6 offset:96
    ds_read_b64_tr_b16 v[82:83], v6 offset:4320
    ds_read_b64_tr_b16 v[36:37], v6 offset:33792
    ds_read_b64_tr_b16 v[38:39], v6 offset:38016
    ds_read_b64_tr_b16 v[52:53], v6 offset:33824
    ds_read_b64_tr_b16 v[54:55], v6 offset:38048
    ds_read_b64_tr_b16 v[68:69], v6 offset:33856
    ds_read_b64_tr_b16 v[70:71], v6 offset:38080
    ds_read_b64_tr_b16 v[84:85], v6 offset:33888
    ds_read_b64_tr_b16 v[86:87], v6 offset:38112
    ds_read_b64_tr_b16 v[40:41], v7 offset:0
    ds_read_b64_tr_b16 v[42:43], v7 offset:4224
    ds_read_b64_tr_b16 v[56:57], v7 offset:32
    ds_read_b64_tr_b16 v[58:59], v7 offset:4256
    ds_read_b64_tr_b16 v[72:73], v7 offset:64
    ds_read_b64_tr_b16 v[74:75], v7 offset:4288
    ds_read_b64_tr_b16 v[88:89], v7 offset:96
    ds_read_b64_tr_b16 v[90:91], v7 offset:4320
    ds_read_b64_tr_b16 v[44:45], v7 offset:33792
    ds_read_b64_tr_b16 v[46:47], v7 offset:38016
    ds_read_b64_tr_b16 v[60:61], v7 offset:33824
    ds_read_b64_tr_b16 v[62:63], v7 offset:38048
    ds_read_b64_tr_b16 v[76:77], v7 offset:33856
    ds_read_b64_tr_b16 v[78:79], v7 offset:38080
    ds_read_b64_tr_b16 v[92:93], v7 offset:33888
    ds_read_b64_tr_b16 v[94:95], v7 offset:38112
    s_cmp_lg_u32 s83, 0
    s_cbranch_scc1 L_hdone_51
L_cw_52:
    ds_read_b32 v3, v9 offset:27932
    s_add_u32 s82, s82, 1
    s_cmp_gt_u32 s82, 0x60000000
    s_cbranch_scc1 L_cwok_53
    s_waitcnt lgkmcnt(0)
    v_readfirstlane_b32 s100, v3
    s_cmp_ge_u32 s100, 4
    s_cbranch_scc0 L_cw_52
L_cwok_53:
    s_waitcnt lgkmcnt(0)
    v_lshlrev_b32 v4, 2, v0
    ds_read_b32 v244, v4 offset:16640
    ds_read_b32 v245, v4 offset:16896
    ds_read_b32 v246, v4 offset:17152
    ds_read_b32 v247, v4 offset:17408
    v_and_b32 v5, 3, v0
    v_lshlrev_b32 v5, 6, v5
    v_lshrrev_b32 v4, 2, v0
    v_lshl_add_u32 v5, v4, 1, v5
    v_lshlrev_b32 v11, 16, v11
    s_waitcnt lgkmcnt(0)
    v_add_f32 v244, v244, v245
    v_add_f32 v246, v246, v247
    v_add_f32 v244, v244, v246
    v_cvt_pk_bf16_f32 v244, v244, v244
    v_lshlrev_b32 v244, 16, v244
    v_add_f32 v244, v244, v11
    v_cvt_pk_bf16_f32 v244, v244, v244
    v_lshlrev_b32 v244, 16, v244
    v_max_f32 v244, 0, v244
    v_mul_f32 v244, v244, v244
    v_cvt_pk_bf16_f32 v244, v244, v244
    s_cmp_lt_u32 s63, 1792
    s_cselect_b32 exec_lo, -1, 0
    s_mov_b32 exec_hi, 0
    ds_write_b16 v5, v244 offset:27648
    s_mov_b64 exec, -1
    v_mov_b32 v3, 1
    s_mov_b64 exec, 1
    ds_add_u32 v9, v3 offset:27940
    s_mov_b64 exec, -1
L_hdone_51:
L_cw_54:
    ds_read_b32 v3, v9 offset:27940
    s_add_u32 s82, s82, 1
    s_cmp_gt_u32 s82, 0x60000000
    s_cbranch_scc1 L_cwok_55
    s_waitcnt lgkmcnt(0)
    v_readfirstlane_b32 s100, v3
    s_cmp_ge_u32 s100, 1
    s_cbranch_scc0 L_cw_54
L_cwok_55:
    s_waitcnt lgkmcnt(0)
    v_and_b32 v3, 3, v1
    v_lshlrev_b32 v3, 6, v3
    v_lshl_add_u32 v3, v2, 4, v3
    ds_read_b128 v[248:251], v3 offset:27648
    s_waitcnt lgkmcnt(0)
    v_mfma_f32_16x16x32_bf16 v[16:19], v[160:163], v[248:251], 0
    v_mfma_f32_16x16x32_bf16 v[20:23], v[164:167], v[248:251], 0
    v_mfma_f32_16x16x32_bf16 v[24:27], v[168:171], v[248:251], 0
    v_mfma_f32_16x16x32_bf16 v[28:31], v[172:175], v[248:251], 0
    v_and_b32 v6, 3, v1
    v_lshlrev_b32 v7, 8, v6
    v_lshl_add_u32 v7, v2, 4, v7
    v_lshlrev_b32 v6, 11, v6
    v_lshl_add_u32 v6, v2, 4, v6
    v_lshrrev_b32 v5, 2, v1
    v_lshl_add_u32 v6, v5, 6, v6
    s_mul_i32 s72, s2, 8320
    s_lshl_b32 s73, s56, 8
    s_add_u32 s72, s72, s73
    s_add_u32 s72, s72, 10485760
    v_cmp_eq_u32 s[80:81], 1, v5
    v_cmp_eq_u32 s[76:77], 2, v5
    v_cmp_eq_u32 s[78:79], 3, v5
    v_and_b32 v4, 3, v1
    v_lshlrev_b32 v3, 7, v4
    v_lshl_add_u32 v3, v2, 4, v3
    s_lshl_b32 s73, s83, 6
    v_add_u32 v4, s73, v7
    s_barrier
    ds_read_b128 v[192:195], v3 offset:22528
    ds_read_b128 v[196:199], v3 offset:22592
    s_waitcnt lgkmcnt(0)
    v_mfma_f32_16x16x32_bf16 v[200:203], v[176:179], v[192:195], 0
    v_mfma_f32_16x16x32_bf16 v[204:207], v[180:183], v[192:195], 0
    v_mfma_f32_16x16x32_bf16 v[200:203], v[184:187], v[196:199], v[200:203]
    v_mfma_f32_16x16x32_bf16 v[204:207], v[188:191], v[196:199], v[204:207]
    s_nop 7
    v_cvt_pk_bf16_f32 v192, v200, v204
    v_cvt_pk_bf16_f32 v193, v201, v205
    v_cvt_pk_bf16_f32 v194, v202, v206
    v_cvt_pk_bf16_f32 v195, v203, v207
    ds_write_b128 v4, v[192:195] offset:23040
    s_waitcnt lgkmcnt(0)
    s_barrier
    ds_read_b128 v[224:227], v7 offset:23040
    ds_read_b128 v[228:231], v7 offset:23104
    ds_read_b128 v[232:235], v7 offset:23168
    ds_read_b128 v[236:239], v7 offset:23232
    s_waitcnt lgkmcnt(3)
    v_mfma_f32_16x16x32_bf16 v[16:19], v[32:35], v[224:227], v[16:19]
    v_mfma_f32_16x16x32_bf16 v[20:23], v[48:51], v[224:227], v[20:23]
    v_mfma_f32_16x16x32_bf16 v[24:27], v[64:67], v[224:227], v[24:27]
    v_mfma_f32_16x16x32_bf16 v[28:31], v[80:83], v[224:227], v[28:31]
    s_waitcnt lgkmcnt(2)
    v_mfma_f32_16x16x32_bf16 v[16:19], v[36:39], v[228:231], v[16:19]
    v_mfma_f32_16x16x32_bf16 v[20:23], v[52:55], v[228:231], v[20:23]
    v_mfma_f32_16x16x32_bf16 v[24:27], v[68:71], v[228:231], v[24:27]
    v_mfma_f32_16x16x32_bf16 v[28:31], v[84:87], v[228:231], v[28:31]
    s_waitcnt lgkmcnt(1)
    v_mfma_f32_16x16x32_bf16 v[16:19], v[40:43], v[232:235], v[16:19]
    v_mfma_f32_16x16x32_bf16 v[20:23], v[56:59], v[232:235], v[20:23]
    v_mfma_f32_16x16x32_bf16 v[24:27], v[72:75], v[232:235], v[24:27]
    v_mfma_f32_16x16x32_bf16 v[28:31], v[88:91], v[232:235], v[28:31]
    s_waitcnt lgkmcnt(0)
    v_mfma_f32_16x16x32_bf16 v[16:19], v[44:47], v[236:239], v[16:19]
    v_mfma_f32_16x16x32_bf16 v[20:23], v[60:63], v[236:239], v[20:23]
    v_mfma_f32_16x16x32_bf16 v[24:27], v[76:79], v[236:239], v[24:27]
    v_mfma_f32_16x16x32_bf16 v[28:31], v[92:95], v[236:239], v[28:31]
    s_nop 5
    v_cndmask_b32 v240, v16, v20, s[80:81]
    v_cndmask_b32 v241, v17, v21, s[80:81]
    v_cndmask_b32 v242, v18, v22, s[80:81]
    v_cndmask_b32 v243, v19, v23, s[80:81]
    v_cndmask_b32 v240, v240, v24, s[76:77]
    v_cndmask_b32 v241, v241, v25, s[76:77]
    v_cndmask_b32 v242, v242, v26, s[76:77]
    v_cndmask_b32 v243, v243, v27, s[76:77]
    v_cndmask_b32 v240, v240, v28, s[78:79]
    v_cndmask_b32 v241, v241, v29, s[78:79]
    v_cndmask_b32 v242, v242, v30, s[78:79]
    v_cndmask_b32 v243, v243, v31, s[78:79]
    v_bfi_b32 v240, s68, v240, v12
    v_bfi_b32 v241, s68, v241, v13
    v_bfi_b32 v242, s68, v242, v14
    v_bfi_b32 v243, s68, v243, v15
    buffer_store_dwordx4 v[240:243], v6, s[52:55], s72 offen sc1
    s_cmp_ge_u32 s2, 64
    s_cbranch_scc1 L_exit_56
    v_lshrrev_b32 v10, 3, v0
    v_mul_u32_u24 v10, 8320, v10
    v_and_b32 v11, 7, v0
    v_lshl_add_u32 v10, v11, 4, v10
    s_mul_i32 s73, s56, 266240
    s_lshl_b32 s75, s2, 7
    s_add_u32 s73, s73, s75
    s_add_u32 s73, s73, 10485760
    s_add_u32 s74, s73, 66560
    s_add_u32 s78, s73, 133120
    s_add_u32 s79, s73, 199680
    s_sleep 20
    buffer_load_dwordx4 v[32:35], v10, s[52:55], s73 offen sc1
    buffer_load_dwordx4 v[36:39], v10, s[52:55], s74 offen sc1
    buffer_load_dwordx4 v[40:43], v10, s[52:55], s78 offen sc1
    buffer_load_dwordx4 v[44:47], v10, s[52:55], s79 offen sc1
    s_mov_b32 s101, 15
    s_waitcnt vmcnt(0)
L_g_57:
    s_bitcmp1_b32 s101, 0
    s_cbranch_scc0 L_gs_59
    v_xor_b32 v32, s64, v32
    v_xor_b32 v33, s65, v33
    v_xor_b32 v34, s66, v34
    v_xor_b32 v35, s67, v35
    v_or3_b32 v3, v32, v33, v34
    v_or_b32 v3, v3, v35
    v_and_b32 v3, 0xfff, v3
    v_cmp_ne_u32 vcc, 0, v3
    s_bitset0_b32 s101, 0
    s_cbranch_vccz L_gs_59
    s_bitset1_b32 s101, 0
    buffer_load_dwordx4 v[32:35], v10, s[52:55], s73 offen sc1
L_gs_59:
    s_bitcmp1_b32 s101, 1
    s_cbranch_scc0 L_gs_60
    v_xor_b32 v36, s64, v36
    v_xor_b32 v37, s65, v37
    v_xor_b32 v38, s66, v38
    v_xor_b32 v39, s67, v39
    v_or3_b32 v3, v36, v37, v38
    v_or_b32 v3, v3, v39
    v_and_b32 v3, 0xfff, v3
    v_cmp_ne_u32 vcc, 0, v3
    s_bitset0_b32 s101, 1
    s_cbranch_vccz L_gs_60
    s_bitset1_b32 s101, 1
    buffer_load_dwordx4 v[36:39], v10, s[52:55], s74 offen sc1
L_gs_60:
    s_bitcmp1_b32 s101, 2
    s_cbranch_scc0 L_gs_61
    v_xor_b32 v40, s64, v40
    v_xor_b32 v41, s65, v41
    v_xor_b32 v42, s66, v42
    v_xor_b32 v43, s67, v43
    v_or3_b32 v3, v40, v41, v42
    v_or_b32 v3, v3, v43
    v_and_b32 v3, 0xfff, v3
    v_cmp_ne_u32 vcc, 0, v3
    s_bitset0_b32 s101, 2
    s_cbranch_vccz L_gs_61
    s_bitset1_b32 s101, 2
    buffer_load_dwordx4 v[40:43], v10, s[52:55], s78 offen sc1
L_gs_61:
    s_bitcmp1_b32 s101, 3
    s_cbranch_scc0 L_gs_62
    v_xor_b32 v44, s64, v44
    v_xor_b32 v45, s65, v45
    v_xor_b32 v46, s66, v46
    v_xor_b32 v47, s67, v47
    v_or3_b32 v3, v44, v45, v46
    v_or_b32 v3, v3, v47
    v_and_b32 v3, 0xfff, v3
    v_cmp_ne_u32 vcc, 0, v3
    s_bitset0_b32 s101, 3
    s_cbranch_vccz L_gs_62
    s_bitset1_b32 s101, 3
    buffer_load_dwordx4 v[44:47], v10, s[52:55], s79 offen sc1
L_gs_62:
    s_cmp_eq_u32 s101, 0
    s_cbranch_scc1 L_gdone_58
    s_add_u32 s82, s82, 0x10000
    s_cmp_gt_u32 s82, 0x40000000
    s_cbranch_scc1 L_gdone_58
    s_waitcnt vmcnt(0)
    s_branch L_g_57
L_gdone_58:
    v_pk_add_f32 v[32:33], v[32:33], v[36:37]
    v_pk_add_f32 v[34:35], v[34:35], v[38:39]
    v_pk_add_f32 v[40:41], v[40:41], v[44:45]
    v_pk_add_f32 v[42:43], v[42:43], v[46:47]
    v_pk_add_f32 v[32:33], v[32:33], v[40:41]
    v_pk_add_f32 v[34:35], v[34:35], v[42:43]
    v_lshlrev_b32 v11, 4, v11
    v_and_b32 v4, 1, v2
    v_permlane32_swap_b32 v32, v33
    v_permlane32_swap_b32 v34, v35
    v_add_f32 v32, v32, v33
    v_add_f32 v34, v34, v35
    v_lshl_add_u32 v11, v4, 3, v11
    v_lshrrev_b32 v4, 1, v2
    v_permlane16_swap_b32 v32, v34
    v_add_f32 v32, v32, v34
    v_lshl_add_u32 v11, v4, 2, v11
    s_lshl_b32 s74, s56, 7
    v_add_f32 v32, v32, v32 row_ror:8
    v_add_u32 v11, s74, v11
    ds_write_b32 v11, v32 offset:16640
    s_waitcnt lgkmcnt(0)
    s_barrier
L_exit_56:
L_end:
    s_endpgm
.section .rodata,"a"
.p2align 6
.amdhsa_kernel parallel_sum__compressed_kv_cla__dense_activation_squared_relu__decode_kernel
  .amdhsa_next_free_vgpr 256
  .amdhsa_next_free_sgpr 102
  .amdhsa_accum_offset 256
  .amdhsa_group_segment_fixed_size 0
  .amdhsa_kernarg_size 112
  .amdhsa_user_sgpr_count 2
  .amdhsa_user_sgpr_kernarg_segment_ptr 1
  .amdhsa_system_sgpr_workgroup_id_x 1
.end_amdhsa_kernel
```
